```python
import torch

def _softmax(x, axis=-1):
    return torch.softmax(x, dim=axis)
def _gelu(x):
    return torch.nn.functional.gelu(x, approximate="tanh")
def _silu(x):
    return torch.nn.functional.silu(x)
def _sigmoid(x):
    return torch.sigmoid(x)
def _layernorm(x, axis=-1, eps=1e-5):
    m = x.mean(dim=axis, keepdim=True)
    v = x.var(dim=axis, keepdim=True, unbiased=False)
    return (x - m) / torch.sqrt(v + eps)
def _scatter_add(tgt, idx, src, axis=0):
    return tgt.clone().index_add_(axis, idx, src)
def _segment_sum(src, seg, n):
    out = torch.zeros((n,) + src.shape[1:], dtype=src.dtype)
    return out.index_add_(0, seg, src)
def _pad(x, pw):
    flat = tuple(v for pair in reversed(pw) for v in pair)
    return torch.nn.functional.pad(x, flat)

kernel_name = 'recurrent_scan__gqa_block_cached__glu_gated_geglu__decode'

def setup_inputs():

    _w = (lambda a: (lambda t: t.to(torch.bfloat16) if t.is_floating_point() else t)(torch.as_tensor(a)))
    def _A_setup():
        B, Sq, D = 1, 1, 1024
        Hq, Hkv, Sk, Dh = 32, 4, 65536, 128
        assert Hq % Hkv == 0, (Hq, Hkv)
        return {
            "x": _w((lambda *s: torch.randn(*s, dtype=torch.bfloat16) * 0.4)(B, Sq, D)),
            "k_cache": _w((lambda *s: torch.randn(*s, dtype=torch.bfloat16) * 1.6)(B, Hkv, Sk, Dh)),
            "v_cache": _w((lambda *s: torch.randn(*s, dtype=torch.bfloat16) * 1.6)(B, Hkv, Sk, Dh)),
            "wq": _w((lambda *s: torch.randn(*s, dtype=torch.bfloat16) * 1.6)(D, Hq * Dh) * (D ** -0.5)),
            "wo": _w((lambda *s: torch.randn(*s, dtype=torch.bfloat16) * 1.6)(Hq * Dh, D) * ((Hq * Dh) ** -0.5)),
        }
    _A_in = _A_setup()

    def _B_setup():
        B, S, Dm, Df = 1, 1, 1024, 3584
        return {
            "x": _w((lambda *s: torch.randn(*s, dtype=torch.bfloat16) * 0.4)(B, S, Dm)),
            "w_gate": _w((lambda *s: torch.randn(*s, dtype=torch.bfloat16) * 1.6)(Dm, Df) * (Dm ** -0.5)),
            "w_up": _w((lambda *s: torch.randn(*s, dtype=torch.bfloat16) * 1.6)(Dm, Df) * (Dm ** -0.5)),
            "w_down": _w((lambda *s: torch.randn(*s, dtype=torch.bfloat16) * 1.6)(Df, Dm) * (Df ** -0.5)),
        }
    _B_in = _B_setup()

    return {
        "A_x": _A_in["x"],
        "A_k_cache": _A_in["k_cache"],
        "A_v_cache": _A_in["v_cache"],
        "A_wq": _A_in["wq"],
        "A_wo": _A_in["wo"],
        "B_x": _B_in["x"],
        "B_w_gate": _B_in["w_gate"],
        "B_w_up": _B_in["w_up"],
        "B_w_down": _B_in["w_down"],
    }

def reference(A_x, A_k_cache, A_v_cache, A_wq, A_wo, B_x, B_w_gate, B_w_up, B_w_down):
    def _A_ref(x, k_cache, v_cache, wq, wo):
        B, Sq, D = x.shape
        Hq, Dh = 32, 128
        Hkv = k_cache.shape[1]
        rep = Hq // Hkv
        q = (lambda x, *d: x.permute(*d))((x @ wq).reshape(B, Sq, Hq, Dh), 0, 2, 1, 3)
        k = (lambda x, n, axis: torch.repeat_interleave(x, n, dim=axis))(k_cache, rep, axis=1)
        v = (lambda x, n, axis: torch.repeat_interleave(x, n, dim=axis))(v_cache, rep, axis=1)
        scores = torch.einsum("bhqd,bhkd->bhqk", q, k) * (Dh ** -0.5)
        p = _softmax(scores, axis=-1)
        o = torch.einsum("bhqk,bhkd->bhqd", p, v)
        return (lambda x, *d: x.permute(*d))(o, 0, 2, 1, 3).reshape(B, Sq, Hq * Dh) @ wo

    def _B_ref(x, w_gate, w_up, w_down):
        g = torch.einsum("bsd,df->bsf", x, w_gate)
        u = torch.einsum("bsd,df->bsf", x, w_up)
        h = _gelu(g) * u
        return torch.einsum("bsf,fd->bsd", h, w_down)

    x = A_x
    xn = _layernorm(x, axis=-1)
    s = _A_ref(xn, A_k_cache, A_v_cache, A_wq, A_wo)
    g = _silu(_B_ref(xn, B_w_gate, B_w_up, B_w_down))
    return x + s * g
```

```asm
; @launch grid=(256,1,1) block=(512,1,1) lds=147168
.amdgcn_target "amdgcn-amd-amdhsa--gfx950"
.text
.p2align 12
.globl recurrent_scan__gqa_block_cached__glu_gated_geglu__decode_kernel
.p2align 8
.type recurrent_scan__gqa_block_cached__glu_gated_geglu__decode_kernel,@function
recurrent_scan__gqa_block_cached__glu_gated_geglu__decode_kernel:
    s_load_dwordx16 s[4:19], s[0:1], 0
    s_load_dwordx8 s[20:27], s[0:1], 64
    s_cmp_ge_u32 s2, 256
    s_cbranch_scc1 L_end0
    v_and_b32 v2, 60, v0
    v_add_u32 v2, 147104, v2
    v_mov_b32 v5, 0
    ds_write_b32 v2, v5
    v_lshrrev_b32 v1, 6, v0
    v_and_b32 v0, 63, v0
    v_readfirstlane_b32 s3, v1
    s_bfe_u32 s29, s2, 0x20003
    s_lshr_b32 s28, s2, 6
    s_bfe_u32 s58, s2, 0x10005
    s_and_b32 s59, s2, 7
    s_lshl3_add_u32 s30, s58, s59
    s_and_b32 s32, s2, 63
    s_bitcmp1_b32 s3, 2
    s_cbranch_scc1 L_str
    s_setprio 3
    s_and_b32 s3, s3, 3
    v_lshlrev_b32 v1, 5, v0
    v_lshrrev_b32 v2, 3, v0
    v_and_b32 v4, 7, v0
    v_lshlrev_b32 v4, 4, v4
    v_lshl_add_u32 v4, v2, 16, v4
    s_lshl2_add_u32 s58, s29, s3
    s_lshl_b32 s59, s58, 7
    v_lshl_add_u32 v3, v2, 4, s59
    s_lshl_b32 s58, s58, 19
    s_lshl4_add_u32 s59, s28, s30
    s_lshl_b32 s59, s59, 7
    s_add_u32 s58, s58, s59
    s_waitcnt lgkmcnt(0)
    global_load_dwordx4 v[8:11], v1, s[4:5]
    global_load_dwordx4 v[12:15], v1, s[4:5] offset:16
    global_load_dwordx4 v[16:19], v3, s[4:5]
    s_add_u32 s10, s10, s58
    s_addc_u32 s11, s11, 0
    global_load_dwordx4 v[20:23], v4, s[10:11] nt
    v_add_u32 v4, 0x2000, v4
    global_load_dwordx4 v[24:27], v4, s[10:11] nt
    v_add_u32 v4, 0x2000, v4
    global_load_dwordx4 v[28:31], v4, s[10:11] nt
    v_add_u32 v4, 0x2000, v4
    global_load_dwordx4 v[32:35], v4, s[10:11] nt
    v_add_u32 v4, 0x2000, v4
    global_load_dwordx4 v[36:39], v4, s[10:11] nt
    v_add_u32 v4, 0x2000, v4
    global_load_dwordx4 v[40:43], v4, s[10:11] nt
    v_add_u32 v4, 0x2000, v4
    global_load_dwordx4 v[44:47], v4, s[10:11] nt
    v_add_u32 v4, 0x2000, v4
    global_load_dwordx4 v[48:51], v4, s[10:11] nt
    s_load_dword s36, s[26:27], 0
    s_barrier
    s_branch L_aux
L_end0:
    s_endpgm
L_str:
    s_and_b32 s3, s3, 3
    s_mov_b64 exec, 0
    s_cmp_eq_u32 s3, 0
    s_cbranch_scc1 PA0
    s_cmp_eq_u32 s3, 1
    s_cbranch_scc1 PA1
    s_cmp_eq_u32 s3, 2
    s_cbranch_scc1 PS0
    s_branch L_ret1
L_ret1:
    s_mov_b64 exec, -1
    s_waitcnt lgkmcnt(0)
    s_barrier
    s_load_dword s36, s[26:27], 0
    v_mov_b32 v233, 147104
    v_mov_b32 v234, 1
    v_mov_b32 v242, 2
    s_cmp_lg_u32 s3, 0
    s_cbranch_scc1 L_noini2
    s_cmp_lg_u32 s32, 0
    s_cbranch_scc1 L_noinit
    s_mul_i32 s59, s28, 2048
    s_add_u32 s59, s59, 3145728
    v_mul_u32_u24 v22, 256, v0
    v_add_u32 v22, s59, v22
    v_mov_b32 v23, 0
    s_mov_b64 exec, 15
    v_mov_b32 v23, 384
    s_mov_b64 exec, 31
    global_store_dword v22, v23, s[26:27] sc1
    s_waitcnt vmcnt(0)
L_noinit:
    s_mov_b64 exec, 1
    ds_add_u32 v233, v234 offset:20
    s_mov_b64 exec, -1
L_noini2:
    s_mov_b64 exec, 0
    s_cmp_eq_u32 s3, 0
    s_cbranch_scc1 PA2
    s_cmp_eq_u32 s3, 1
    s_cbranch_scc1 PA3
    s_cmp_eq_u32 s3, 2
    s_cbranch_scc1 PL0
    s_branch PL1
L_ret2:
    s_mov_b64 exec, -1
    v_lshrrev_b32 v1, 4, v0
    v_and_b32 v2, 15, v0
    v_lshlrev_b32 v3, 1, v1
    v_xor_b32 v2, v2, v3
    v_lshlrev_b32 v2, 4, v2
    v_lshl_add_u32 v2, v1, 8, v2
    v_xor_b32 v3, 0x80, v2
    v_add_u32 v4, 0x1000, v2
    v_add_u32 v5, 0x1000, v3
    s_mul_i32 s38, s28, 72
    s_add_u32 s38, s38, s3
    s_lshl2_add_u32 s35, s32, s38
    s_lshl_b32 s59, s28, 24
    s_lshl_b32 s34, s3, 15
    s_add_u32 s54, s6, s59
    s_addc_u32 s55, s7, 0
    s_add_u32 s56, s8, s59
    s_addc_u32 s57, s9, 0
    s_lshr_b32 s39, s2, 3
    s_add_u32 s39, s39, s3
    s_and_b32 s39, s39, 3
    s_lshr_b32 s58, s32, 3
    s_xor_b32 s35, s32, s58
    s_lshl_b32 s58, s39, 6
    s_add_u32 s35, s35, s58
    s_add_u32 s35, s35, s38
    s_sub_u32 s35, s35, s3
    s_lshl_b32 s39, s39, 1
    s_add_u32 s39, s39, 2
    s_lshl4_add_u32 s31, s28, s30
    s_mov_b32 s42, 114688
    s_lshl2_add_u32 s59, s29, s3
    s_lshl_b32 s59, s59, 7
    s_mul_i32 s58, s31, 114688
    s_add_u32 s58, s58, s59
    s_add_u32 s40, s20, s58
    s_addc_u32 s41, s21, 0
    s_mov_b32 s43, 0x20000
    s_lshl4_add_u32 s58, s28, s30
    s_lshl_b32 s58, s58, 17
    s_add_u32 s58, s58, s59
    s_add_u32 s44, s12, s58
    s_addc_u32 s45, s13, 0
    s_mov_b32 s46, 131072
    s_mov_b32 s47, 0x20000
    s_movk_i32 s51, 0x1000
    s_movk_i32 s52, 0x2000
    s_movk_i32 s53, 0x3000
    v_lshrrev_b32 v22, 3, v0
    v_and_b32 v23, 7, v0
    v_lshlrev_b32 v23, 4, v23
    v_lshl_add_u32 v6, v22, 14, v23
    v_lshlrev_b32 v230, 5, v22
    v_add_u32 v230, 145920, v230
    v_lshlrev_b32 v237, 4, v22
    v_add_u32 v237, 146976, v237
    s_lshl_b32 s58, s3, 15
    v_and_b32 v22, 15, v0
    v_and_b32 v23, 7, v0
    v_lshlrev_b32 v23, 1, v23
    v_xor_b32 v23, v23, v1
    v_lshlrev_b32 v23, 4, v23
    v_lshl_add_u32 v8, v22, 8, v23
    v_add_u32 v8, s58, v8
    v_xor_b32 v9, 64, v8
    v_xor_b32 v10, 0x80, v8
    v_xor_b32 v11, 0xc0, v8
    s_add_u32 s58, s58, 0x4000
    v_lshrrev_b32 v22, 2, v0
    v_and_b32 v23, 7, v22
    v_lshlrev_b32 v23, 5, v23
    v_lshl_add_u32 v12, v22, 8, v23
    v_and_b32 v23, 3, v0
    v_lshl_add_u32 v12, v23, 3, v12
    v_add_u32 v12, s58, v12
    v_xor_b32 v13, 32, v12
    v_xor_b32 v14, 64, v12
    v_xor_b32 v15, 96, v12
    v_xor_b32 v16, 128, v12
    v_xor_b32 v17, 160, v12
    v_xor_b32 v18, 192, v12
    v_xor_b32 v19, 224, v12
    v_mov_b32 v20, 0xff7f0000
    v_mov_b32 v21, 0
    v_mov_b32 v124, 0
    v_mov_b32 v125, 0
    v_mov_b32 v126, 0
    v_mov_b32 v127, 0
    v_mov_b32 v128, 0
    v_mov_b32 v129, 0
    v_mov_b32 v130, 0
    v_mov_b32 v131, 0
    v_mov_b32 v132, 0
    v_mov_b32 v133, 0
    v_mov_b32 v134, 0
    v_mov_b32 v135, 0
    v_mov_b32 v136, 0
    v_mov_b32 v137, 0
    v_mov_b32 v138, 0
    v_mov_b32 v139, 0
    v_mov_b32 v140, 0
    v_mov_b32 v141, 0
    v_mov_b32 v142, 0
    v_mov_b32 v143, 0
    v_mov_b32 v144, 0
    v_mov_b32 v145, 0
    v_mov_b32 v146, 0
    v_mov_b32 v147, 0
    v_mov_b32 v148, 0
    v_mov_b32 v149, 0
    v_mov_b32 v150, 0
PS0:
    s_cbranch_execz L_ret1
    v_mov_b32 v151, 0
    v_mov_b32 v152, 0
    v_mov_b32 v153, 0
    v_mov_b32 v154, 0
    v_mov_b32 v155, 0
    s_waitcnt lgkmcnt(0)
    v_and_b32 v112, 1, v0
    v_cmp_eq_u32 vcc, 1, v112
    v_mov_b32 v113, 0x0c0c0100
    v_mov_b32 v114, 0x01000c0c
    v_cndmask_b32 v113, v113, v114, vcc
    v_mov_b32 v114, 0x0c0c0302
    v_mov_b32 v115, 0x03020c0c
    v_cndmask_b32 v114, v114, v115, vcc
    v_bfe_u32 v112, v0, 1, 2
    v_mov_b32 v115, 0x0c0c0c0c
    v_cmp_eq_u32 vcc, 0, v112
    s_nop 1
    v_cndmask_b32 v220, v115, v113, vcc
    v_cndmask_b32 v221, v115, v114, vcc
    v_cmp_eq_u32 vcc, 1, v112
    s_nop 1
    v_cndmask_b32 v222, v115, v113, vcc
    v_cndmask_b32 v223, v115, v114, vcc
    v_cmp_eq_u32 vcc, 2, v112
    s_nop 1
    v_cndmask_b32 v224, v115, v113, vcc
    v_cndmask_b32 v225, v115, v114, vcc
    v_cmp_eq_u32 vcc, 3, v112
    s_nop 1
    v_cndmask_b32 v226, v115, v113, vcc
    v_cndmask_b32 v227, v115, v114, vcc
    v_lshlrev_b32 v7, 4, v0
    v_add_u32 v7, 131072, v7
    v_lshlrev_b32 v240, 3, v0
    v_add_u32 v240, 135168, v240
    s_lshl_b32 s58, s28, 10
    s_add_u32 s58, s58, s32
    s_mul_i32 s58, s58, 384
    s_add_u32 s58, s58, 1048576
    v_and_b32 v22, 7, v0
    v_bfe_u32 v23, v0, 3, 1
    v_mul_u32_u24 v231, 49152, v22
    v_add_u32 v231, s58, v231
    v_mul_u32_u24 v232, 24576, v23
    v_add_u32 v232, v232, v231
    v_lshl_add_u32 v231, v23, 6, v231
    v_lshl_add_u32 v231, v1, 4, v231
    v_add_u32 v238, 24576, v231
    s_lshl_b32 s58, s28, 13
    s_add_u32 s58, s58, 262144
    v_lshl_add_u32 v239, v0, 7, s58
    s_mul_i32 s58, s28, 2048
    s_add_u32 s58, s58, 3146752
    s_add_u32 s14, s26, s58
    s_addc_u32 s15, s27, 0
    v_mov_b32 v235, 0xfffffc00
    s_lshl3_add_u32 s58, s28, s3
    s_mul_i32 s58, s58, 256
    s_add_u32 s58, s58, 3145728
    s_add_u32 s48, s26, s58
    s_addc_u32 s49, s27, 0
    s_lshl2_add_u32 s58, s29, s3
    s_lshl_b32 s58, s58, 15
    s_add_u32 s58, s58, 524288
    v_bfe_u32 v22, v0, 2, 1
    v_lshl_add_u32 v228, v22, 14, s58
    v_and_b32 v22, 3, v0
    v_lshl_add_u32 v228, v22, 5, v228
    v_bfe_u32 v22, v0, 4, 1
    v_lshl_add_u32 v228, v22, 4, v228
    s_add_u32 s59, s31, 64
    s_lshl_b32 s59, s59, 7
    v_add_u32 v229, s59, v228
    s_lshl4_add_u32 s58, s28, s30
    s_lshl_b32 s58, s58, 7
    v_add_u32 v228, s58, v228
    s_add_u32 s36, s36, 0x01010101
    s_lshr_b32 s16, s36, 8
    s_lshr_b32 s17, s36, 16
    s_lshr_b32 s18, s36, 24
    s_mov_b32 s33, 0
    s_mov_b32 s60, 0x3db504f3
    s_mov_b32 s61, 0x3fb8aa3b
    s_mov_b32 s10, 0
    s_mov_b32 s20, 0xff00ff00
    s_mov_b32 s21, 0xff00ff00
    v_and_b32 v22, 7, v0
    v_lshlrev_b32 v22, 8, v22
    v_lshl_add_u32 v22, v1, 4, v22
    v_add_u32 v22, 135680, v22
    s_mov_b32 s13, 0
    s_mov_b32 s62, 0
    s_mov_b32 s11, 0
    s_mov_b32 s19, -1
    s_branch L_loop
L_pro:
    s_waitcnt vmcnt(4)
    s_mov_b64 exec, 1
    ds_add_u32 v233, v234
    s_mov_b64 exec, -1
    s_cmp_eq_u32 s13, 1
    s_cbranch_scc1 L_loop
L_qw:
    s_sleep 1
    ds_read_b32 v23, v233 offset:8
    s_waitcnt lgkmcnt(0)
    v_cmp_ne_u32 vcc, 4, v23
    s_cbranch_vccnz L_qw
    s_branch L_qr
L_t1:
    s_sleep 1
    ds_read_b96 v[108:110], v233
    ds_read_b32 v111, v233 offset:28
    s_waitcnt lgkmcnt(0)
    v_cmp_eq_u32 vcc, 4, v110
    s_cbranch_vccnz L_qr
    v_sub_u32 v108, v108, v111
    v_cmp_gt_i32 vcc, 10, v108
    s_cbranch_vccnz L_t1
    s_branch L_tk
L_qr:
    ds_read_b128 v[24:27], v22 offset:0
    ds_read_b128 v[28:31], v22 offset:64
    ds_read_b128 v[32:35], v22 offset:128
    ds_read_b128 v[36:39], v22 offset:192
    s_mov_b32 s10, 1
    s_mov_b32 s12, s13
    s_branch L_kjob
L_e0:
.p2align 12
L_loop:
PL0:
    s_cbranch_execz L_ret2
    s_cmp_ge_u32 s13, 6
    s_cbranch_scc1 L_dynp
    s_lshl_b32 s58, s13, 9
    s_add_u32 s58, s58, s35
    s_cmp_lt_u32 s13, 3
    s_cselect_b64 s[8:9], s[54:55], s[56:57]
    s_cselect_b32 s59, 0, -1536
    s_add_u32 s59, s59, s58
    s_add_u32 s59, s59, 256
    s_cmp_lt_u32 s13, 3
    s_cselect_b64 s[6:7], s[54:55], s[56:57]
    s_cselect_b32 s63, 0, -1536
    s_add_u32 s58, s58, s63
    s_and_b32 s58, s58, 2047
    s_lshl_b32 s58, s58, 13
    s_and_b32 s59, s59, 2047
    s_lshl_b32 s59, s59, 13
    s_add_u32 s8, s8, s59
    s_addc_u32 s9, s9, 0
    s_add_u32 s6, s6, s58
    s_addc_u32 s7, s7, 0
    s_lshl1_add_u32 s58, s10, s13
    s_cmp_eq_u32 s58, 1
    s_cbranch_scc1 L_t1
    s_cmp_eq_u32 s13, 0
    s_cbranch_scc1 L_tw_c
    s_cmp_lt_u32 s13, 3
    s_cbranch_scc1 L_tk
    v_lshlrev_b32 v112, 16, v156
    v_and_b32 v113, 0xffff0000, v156
    v_lshlrev_b32 v114, 16, v157
    v_and_b32 v115, 0xffff0000, v157
    v_lshlrev_b32 v116, 16, v158
    v_and_b32 v117, 0xffff0000, v158
    v_lshlrev_b32 v118, 16, v159
    v_and_b32 v119, 0xffff0000, v159
    v_sub_f32 v112, v112, v20
    v_sub_f32 v113, v113, v20
    v_sub_f32 v114, v114, v20
    v_sub_f32 v115, v115, v20
    v_sub_f32 v116, v116, v20
    v_sub_f32 v117, v117, v20
    v_sub_f32 v118, v118, v20
    v_sub_f32 v119, v119, v20
    v_mul_f32 v112, s61, v112
    v_mul_f32 v113, s61, v113
    v_mul_f32 v114, s61, v114
    v_mul_f32 v115, s61, v115
    v_mul_f32 v116, s61, v116
    v_mul_f32 v117, s61, v117
    v_mul_f32 v118, s61, v118
    v_mul_f32 v119, s61, v119
    v_exp_f32 v112, v112
    v_exp_f32 v113, v113
    v_exp_f32 v114, v114
    v_exp_f32 v115, v115
    v_exp_f32 v116, v116
    v_exp_f32 v117, v117
    v_exp_f32 v118, v118
    v_exp_f32 v119, v119
    v_cvt_pk_bf16_f32 v120, v112, v113
    v_cvt_pk_bf16_f32 v121, v114, v115
    v_cvt_pk_bf16_f32 v122, v116, v117
    v_cvt_pk_bf16_f32 v123, v118, v119
    v_add_f32 v112, v112, v113
    v_add_f32 v114, v114, v115
    v_add_f32 v116, v116, v117
    v_add_f32 v118, v118, v119
    v_add_f32 v112, v112, v114
    v_add_f32 v116, v116, v118
    v_add_f32 v112, v112, v116
    v_add_f32 v21, v21, v112
    v_lshlrev_b32 v112, 16, v160
    v_and_b32 v113, 0xffff0000, v160
    v_lshlrev_b32 v114, 16, v161
    v_and_b32 v115, 0xffff0000, v161
    v_lshlrev_b32 v116, 16, v162
    v_and_b32 v117, 0xffff0000, v162
    v_lshlrev_b32 v118, 16, v163
    v_and_b32 v119, 0xffff0000, v163
    v_sub_f32 v112, v112, v20
    v_sub_f32 v113, v113, v20
    v_sub_f32 v114, v114, v20
    v_sub_f32 v115, v115, v20
    v_sub_f32 v116, v116, v20
    v_sub_f32 v117, v117, v20
    v_sub_f32 v118, v118, v20
    v_sub_f32 v119, v119, v20
    v_mul_f32 v112, s61, v112
    v_mul_f32 v113, s61, v113
    v_mul_f32 v114, s61, v114
    v_mul_f32 v115, s61, v115
    v_mul_f32 v116, s61, v116
    v_mul_f32 v117, s61, v117
    v_mul_f32 v118, s61, v118
    v_mul_f32 v119, s61, v119
    v_exp_f32 v112, v112
    v_exp_f32 v113, v113
    v_exp_f32 v114, v114
    v_exp_f32 v115, v115
    v_exp_f32 v116, v116
    v_exp_f32 v117, v117
    v_exp_f32 v118, v118
    v_exp_f32 v119, v119
    v_cvt_pk_bf16_f32 v104, v112, v113
    v_cvt_pk_bf16_f32 v105, v114, v115
    v_cvt_pk_bf16_f32 v106, v116, v117
    v_cvt_pk_bf16_f32 v107, v118, v119
    v_add_f32 v112, v112, v113
    v_add_f32 v114, v114, v115
    v_add_f32 v116, v116, v117
    v_add_f32 v118, v118, v119
    v_add_f32 v112, v112, v114
    v_add_f32 v116, v116, v118
    v_add_f32 v112, v112, v116
    v_add_f32 v21, v21, v112
    v_mov_b32 v156, v164
    v_mov_b32 v157, v165
    v_mov_b32 v158, v166
    v_mov_b32 v159, v167
    v_mov_b32 v160, v168
    v_mov_b32 v161, v169
    v_mov_b32 v162, v170
    v_mov_b32 v163, v171
    v_mov_b32 v164, v172
    v_mov_b32 v165, v173
    v_mov_b32 v166, v174
    v_mov_b32 v167, v175
    v_mov_b32 v168, v176
    v_mov_b32 v169, v177
    v_mov_b32 v170, v178
    v_mov_b32 v171, v179
    s_branch L_tk
L_dynp:
    s_lshl2_add_u32 s63, s62, s38
    s_and_b32 s63, s63, 2047
    s_lshl_b32 s63, s63, 13
    s_add_u32 s6, s54, s63
    s_addc_u32 s7, s55, 0
    s_add_u32 s8, s56, s63
    s_addc_u32 s9, s57, 0
L_tk:
    s_mov_b64 exec, 1
    ds_add_rtn_u32 v108, v233, v242 offset:28
    s_mov_b64 exec, -1
    s_waitcnt lgkmcnt(0)
    v_readfirstlane_b32 s39, v108
    s_add_u32 s39, s39, 10
    s_branch L_tw_c
L_tw:
    s_sleep 1
L_tw_c:
    ds_read_b64 v[108:109], v233
    s_waitcnt lgkmcnt(0)
    v_cmp_gt_i32 vcc, s39, v108
    v_cmp_gt_u32 s[58:59], 1, v109
    s_and_b64 vcc, vcc, s[58:59]
    s_cbranch_scc1 L_tw
    s_mov_b32 m0, s34
    s_nop 0
    global_load_lds_dwordx4 v2, s[6:7] offset:0 nt
    global_load_lds_dwordx4 v3, s[6:7] offset:1024 nt
    global_load_lds_dwordx4 v2, s[6:7] offset:2048 nt
    global_load_lds_dwordx4 v3, s[6:7] offset:3072 nt
    s_add_u32 m0, s34, 0x1000
    s_nop 0
    global_load_lds_dwordx4 v4, s[6:7] offset:0 nt
    global_load_lds_dwordx4 v5, s[6:7] offset:1024 nt
    global_load_lds_dwordx4 v4, s[6:7] offset:2048 nt
    global_load_lds_dwordx4 v5, s[6:7] offset:3072 nt
    s_add_u32 s39, s39, 1
    s_branch L_tb_c
L_tb:
    s_sleep 1
L_tb_c:
    ds_read_b64 v[108:109], v233
    s_waitcnt lgkmcnt(0)
    v_cmp_gt_i32 vcc, s39, v108
    v_cmp_gt_u32 s[58:59], 1, v109
    s_and_b64 vcc, vcc, s[58:59]
    s_cbranch_scc1 L_tb
    s_add_u32 m0, s34, 0x2000
    s_nop 0
    global_load_lds_dwordx4 v2, s[8:9] offset:0 nt
    global_load_lds_dwordx4 v3, s[8:9] offset:1024 nt
    global_load_lds_dwordx4 v2, s[8:9] offset:2048 nt
    global_load_lds_dwordx4 v3, s[8:9] offset:3072 nt
    s_add_u32 m0, s34, 0x3000
    s_nop 0
    global_load_lds_dwordx4 v4, s[8:9] offset:0 nt
    global_load_lds_dwordx4 v5, s[8:9] offset:1024 nt
    global_load_lds_dwordx4 v4, s[8:9] offset:2048 nt
    global_load_lds_dwordx4 v5, s[8:9] offset:3072 nt
    s_xor_b32 s34, s34, 0x4000
    s_add_u32 s13, s13, 1
    s_waitcnt vmcnt(12)
    s_mov_b64 exec, 1
    ds_add_u32 v233, v234
    s_mov_b64 exec, -1
    s_cmp_ge_u32 s33, 6
    s_cbranch_scc1 L_mix
    s_cmp_eq_u32 s10, 0
    s_cbranch_scc1 L_pro
    s_cmp_ge_u32 s33, 3
    s_cbranch_scc1 L_vjob
    s_waitcnt vmcnt(8)
L_kjob:
    ds_read_b128 v[40:43], v8 offset:0
    ds_read_b128 v[44:47], v9 offset:0
    ds_read_b128 v[48:51], v10 offset:0
    ds_read_b128 v[52:55], v11 offset:0
    ds_read_b128 v[56:59], v8 offset:4096
    ds_read_b128 v[60:63], v9 offset:4096
    ds_read_b128 v[64:67], v10 offset:4096
    ds_read_b128 v[68:71], v11 offset:4096
    ds_read_b32 v236, v233
    s_waitcnt lgkmcnt(8)
    v_mfma_f32_16x16x32_bf16 v[104:107], v[40:43], v[24:27], 0
    s_waitcnt lgkmcnt(7)
    v_mfma_f32_16x16x32_bf16 v[104:107], v[44:47], v[28:31], v[104:107]
PL1:
    s_cbranch_execz L_ret2
    s_waitcnt lgkmcnt(6)
    v_mfma_f32_16x16x32_bf16 v[104:107], v[48:51], v[32:35], v[104:107]
    s_waitcnt lgkmcnt(5)
    v_mfma_f32_16x16x32_bf16 v[104:107], v[52:55], v[36:39], v[104:107]
    s_waitcnt lgkmcnt(4)
    v_mfma_f32_16x16x32_bf16 v[108:111], v[56:59], v[24:27], 0
    s_waitcnt lgkmcnt(3)
    v_mfma_f32_16x16x32_bf16 v[108:111], v[60:63], v[28:31], v[108:111]
    s_waitcnt lgkmcnt(2)
    v_mfma_f32_16x16x32_bf16 v[108:111], v[64:67], v[32:35], v[108:111]
    s_waitcnt lgkmcnt(1)
    v_mfma_f32_16x16x32_bf16 v[108:111], v[68:71], v[36:39], v[108:111]
    s_cmp_lt_u32 s33, s12
    s_cbranch_scc1 L_nopass
    s_waitcnt vmcnt(4)
    s_mov_b64 exec, 1
    ds_add_u32 v233, v234
    s_mov_b64 exec, -1
L_nopass:
    v_mov_b32 v156, v164
    v_mov_b32 v157, v165
    v_mov_b32 v158, v166
    v_mov_b32 v159, v167
    v_mov_b32 v160, v168
    v_mov_b32 v161, v169
    v_mov_b32 v162, v170
    v_mov_b32 v163, v171
    v_mov_b32 v164, v172
    v_mov_b32 v165, v173
    v_mov_b32 v166, v174
    v_mov_b32 v167, v175
    v_mov_b32 v168, v176
    v_mov_b32 v169, v177
    v_mov_b32 v170, v178
    v_mov_b32 v171, v179
    v_cvt_pk_bf16_f32 v120, v104, v105
    v_cvt_pk_bf16_f32 v121, v106, v107
    v_cvt_pk_bf16_f32 v122, v108, v109
    v_cvt_pk_bf16_f32 v123, v110, v111
    v_lshlrev_b32 v112, 16, v120
    v_and_b32 v113, 0xffff0000, v120
    v_lshlrev_b32 v114, 16, v121
    v_and_b32 v115, 0xffff0000, v121
    v_lshlrev_b32 v116, 16, v122
    v_and_b32 v117, 0xffff0000, v122
    v_lshlrev_b32 v118, 16, v123
    v_and_b32 v119, 0xffff0000, v123
    v_mul_f32 v112, s60, v112
    v_mul_f32 v113, s60, v113
    v_mul_f32 v114, s60, v114
    v_mul_f32 v115, s60, v115
    v_mul_f32 v116, s60, v116
    v_mul_f32 v117, s60, v117
    v_mul_f32 v118, s60, v118
    v_mul_f32 v119, s60, v119
    v_cvt_pk_bf16_f32 v172, v112, v113
    v_cvt_pk_bf16_f32 v173, v114, v115
    v_cvt_pk_bf16_f32 v174, v116, v117
    v_cvt_pk_bf16_f32 v175, v118, v119
    v_lshlrev_b32 v112, 16, v172
    v_and_b32 v113, 0xffff0000, v172
    v_lshlrev_b32 v114, 16, v173
    v_and_b32 v115, 0xffff0000, v173
    v_lshlrev_b32 v116, 16, v174
    v_and_b32 v117, 0xffff0000, v174
    v_lshlrev_b32 v118, 16, v175
    v_and_b32 v119, 0xffff0000, v175
    v_max3_f32 v20, v20, v112, v113
    v_max3_f32 v23, v114, v115, v116
    v_max3_f32 v20, v20, v117, v118
    v_max3_f32 v20, v20, v119, v23
    s_waitcnt vmcnt(0)
    ds_read_b128 v[72:75], v8 offset:8192
    ds_read_b128 v[76:79], v9 offset:8192
    ds_read_b128 v[80:83], v10 offset:8192
    ds_read_b128 v[84:87], v11 offset:8192
    ds_read_b128 v[88:91], v8 offset:12288
    ds_read_b128 v[92:95], v9 offset:12288
    ds_read_b128 v[96:99], v10 offset:12288
    ds_read_b128 v[100:103], v11 offset:12288
    ds_read_b32 v236, v233
    s_waitcnt lgkmcnt(8)
    v_mfma_f32_16x16x32_bf16 v[104:107], v[72:75], v[24:27], 0
    s_waitcnt lgkmcnt(7)
    v_mfma_f32_16x16x32_bf16 v[104:107], v[76:79], v[28:31], v[104:107]
    s_waitcnt lgkmcnt(6)
    v_mfma_f32_16x16x32_bf16 v[104:107], v[80:83], v[32:35], v[104:107]
    s_waitcnt lgkmcnt(5)
    v_mfma_f32_16x16x32_bf16 v[104:107], v[84:87], v[36:39], v[104:107]
    s_waitcnt lgkmcnt(4)
    v_mfma_f32_16x16x32_bf16 v[108:111], v[88:91], v[24:27], 0
    s_waitcnt lgkmcnt(3)
    v_mfma_f32_16x16x32_bf16 v[108:111], v[92:95], v[28:31], v[108:111]
    s_waitcnt lgkmcnt(2)
    v_mfma_f32_16x16x32_bf16 v[108:111], v[96:99], v[32:35], v[108:111]
    s_waitcnt lgkmcnt(1)
    v_mfma_f32_16x16x32_bf16 v[108:111], v[100:103], v[36:39], v[108:111]
    v_xor_b32 v8, 0x4000, v8
    v_xor_b32 v9, 0x4000, v9
    v_xor_b32 v10, 0x4000, v10
    v_xor_b32 v11, 0x4000, v11
    v_cvt_pk_bf16_f32 v120, v104, v105
    v_cvt_pk_bf16_f32 v121, v106, v107
    s_nop 1
    v_cvt_pk_bf16_f32 v122, v108, v109
    v_cvt_pk_bf16_f32 v123, v110, v111
    v_lshlrev_b32 v112, 16, v120
    v_and_b32 v113, 0xffff0000, v120
    v_lshlrev_b32 v114, 16, v121
    v_and_b32 v115, 0xffff0000, v121
    v_lshlrev_b32 v116, 16, v122
    v_and_b32 v117, 0xffff0000, v122
    v_lshlrev_b32 v118, 16, v123
    v_and_b32 v119, 0xffff0000, v123
    v_mul_f32 v112, s60, v112
    v_mul_f32 v113, s60, v113
    v_mul_f32 v114, s60, v114
    v_mul_f32 v115, s60, v115
    v_mul_f32 v116, s60, v116
    v_mul_f32 v117, s60, v117
    v_mul_f32 v118, s60, v118
    v_mul_f32 v119, s60, v119
    v_cvt_pk_bf16_f32 v176, v112, v113
    v_cvt_pk_bf16_f32 v177, v114, v115
    v_cvt_pk_bf16_f32 v178, v116, v117
    v_cvt_pk_bf16_f32 v179, v118, v119
    v_lshlrev_b32 v112, 16, v176
    v_and_b32 v113, 0xffff0000, v176
    v_lshlrev_b32 v114, 16, v177
    v_and_b32 v115, 0xffff0000, v177
    v_lshlrev_b32 v116, 16, v178
    v_and_b32 v117, 0xffff0000, v178
    v_lshlrev_b32 v118, 16, v179
    v_and_b32 v119, 0xffff0000, v179
    v_max3_f32 v20, v20, v112, v113
    v_max3_f32 v23, v114, v115, v116
    v_max3_f32 v20, v20, v117, v118
    v_max3_f32 v20, v20, v119, v23
    s_add_u32 s33, s33, 1
    s_cmp_lt_u32 s33, s13
    s_cbranch_scc1 L_kjob
    s_cmp_lt_u32 s33, 3
    s_cbranch_scc1 L_loop
    v_mov_b32 v23, v20
    s_nop 1
    v_permlane32_swap_b32 v23, v20
    v_max_f32 v20, v20, v23
    v_mov_b32 v23, v20
    s_nop 1
    v_permlane16_swap_b32 v23, v20
    v_max_f32 v20, v20, v23
    v_xor_b32 v8, 0x4000, v8
    v_xor_b32 v9, 0x4000, v9
    v_xor_b32 v10, 0x4000, v10
    v_xor_b32 v11, 0x4000, v11
    s_branch L_loop
L_vjob:
    s_cmp_lg_u32 s33, 5
    s_cbranch_scc1 L_notk
    s_waitcnt vmcnt(12)
    s_mov_b32 s62, 1
    s_atomic_add s62, s[48:49], 0 glc
L_notk:
    s_waitcnt vmcnt(8)
    ds_read_b64_tr_b16 v[40:41], v12 offset:0
    ds_read_b64_tr_b16 v[42:43], v12 offset:4096
    ds_read_b64_tr_b16 v[44:45], v13 offset:0
    ds_read_b64_tr_b16 v[46:47], v13 offset:4096
    ds_read_b64_tr_b16 v[48:49], v14 offset:0
    ds_read_b64_tr_b16 v[50:51], v14 offset:4096
    ds_read_b64_tr_b16 v[52:53], v15 offset:0
    ds_read_b64_tr_b16 v[54:55], v15 offset:4096
    ds_read_b64_tr_b16 v[56:57], v16 offset:0
    ds_read_b64_tr_b16 v[58:59], v16 offset:4096
    ds_read_b64_tr_b16 v[60:61], v17 offset:0
    ds_read_b64_tr_b16 v[62:63], v17 offset:4096
    ds_read_b64_tr_b16 v[64:65], v18 offset:0
    ds_read_b64_tr_b16 v[66:67], v18 offset:4096
    ds_read_b64_tr_b16 v[68:69], v19 offset:0
    ds_read_b64_tr_b16 v[70:71], v19 offset:4096
    ds_read_b32 v236, v233
    s_waitcnt lgkmcnt(14)
    v_mfma_f32_16x16x32_bf16 v[124:127], v[40:43], v[120:123], v[124:127]
PL2:
    s_cbranch_execz L_ret2
    s_waitcnt lgkmcnt(13)
    v_mfma_f32_16x16x32_bf16 v[128:131], v[44:47], v[120:123], v[128:131]
    s_waitcnt lgkmcnt(11)
    v_mfma_f32_16x16x32_bf16 v[132:135], v[48:51], v[120:123], v[132:135]
    s_waitcnt lgkmcnt(9)
    v_mfma_f32_16x16x32_bf16 v[136:139], v[52:55], v[120:123], v[136:139]
    s_waitcnt lgkmcnt(7)
    v_mfma_f32_16x16x32_bf16 v[140:143], v[56:59], v[120:123], v[140:143]
    s_waitcnt lgkmcnt(5)
    v_mfma_f32_16x16x32_bf16 v[144:147], v[60:63], v[120:123], v[144:147]
    s_waitcnt lgkmcnt(3)
    v_mfma_f32_16x16x32_bf16 v[148:151], v[64:67], v[120:123], v[148:151]
    s_waitcnt lgkmcnt(1)
    v_mfma_f32_16x16x32_bf16 v[152:155], v[68:71], v[120:123], v[152:155]
    s_waitcnt vmcnt(4)
    s_mov_b64 exec, 1
    ds_add_u32 v233, v234
    s_mov_b64 exec, -1
    s_waitcnt vmcnt(0)
    ds_read_b64_tr_b16 v[72:73], v12 offset:8192
    ds_read_b64_tr_b16 v[74:75], v12 offset:12288
    ds_read_b64_tr_b16 v[76:77], v13 offset:8192
    ds_read_b64_tr_b16 v[78:79], v13 offset:12288
    ds_read_b64_tr_b16 v[80:81], v14 offset:8192
    ds_read_b64_tr_b16 v[82:83], v14 offset:12288
    ds_read_b64_tr_b16 v[84:85], v15 offset:8192
    ds_read_b64_tr_b16 v[86:87], v15 offset:12288
    ds_read_b64_tr_b16 v[88:89], v16 offset:8192
    ds_read_b64_tr_b16 v[90:91], v16 offset:12288
    ds_read_b64_tr_b16 v[92:93], v17 offset:8192
    ds_read_b64_tr_b16 v[94:95], v17 offset:12288
    ds_read_b64_tr_b16 v[96:97], v18 offset:8192
    ds_read_b64_tr_b16 v[98:99], v18 offset:12288
    ds_read_b64_tr_b16 v[100:101], v19 offset:8192
    ds_read_b64_tr_b16 v[102:103], v19 offset:12288
    ds_read_b32 v236, v233
    s_waitcnt lgkmcnt(14)
    v_mfma_f32_16x16x32_bf16 v[124:127], v[72:75], v[104:107], v[124:127]
    v_xor_b32 v12, 0x4000, v12
    s_waitcnt lgkmcnt(13)
    v_mfma_f32_16x16x32_bf16 v[128:131], v[76:79], v[104:107], v[128:131]
    v_xor_b32 v13, 0x4000, v13
    s_waitcnt lgkmcnt(11)
    v_mfma_f32_16x16x32_bf16 v[132:135], v[80:83], v[104:107], v[132:135]
    v_xor_b32 v14, 0x4000, v14
    s_waitcnt lgkmcnt(9)
    v_mfma_f32_16x16x32_bf16 v[136:139], v[84:87], v[104:107], v[136:139]
    v_xor_b32 v15, 0x4000, v15
    s_waitcnt lgkmcnt(7)
    v_mfma_f32_16x16x32_bf16 v[140:143], v[88:91], v[104:107], v[140:143]
    v_xor_b32 v16, 0x4000, v16
    s_waitcnt lgkmcnt(5)
    v_mfma_f32_16x16x32_bf16 v[144:147], v[92:95], v[104:107], v[144:147]
    v_xor_b32 v17, 0x4000, v17
    s_waitcnt lgkmcnt(3)
    v_mfma_f32_16x16x32_bf16 v[148:151], v[96:99], v[104:107], v[148:151]
    v_xor_b32 v18, 0x4000, v18
    s_waitcnt lgkmcnt(1)
    v_mfma_f32_16x16x32_bf16 v[152:155], v[100:103], v[104:107], v[152:155]
    v_xor_b32 v19, 0x4000, v19
    s_add_u32 s33, s33, 1
L_vend:
    s_waitcnt lgkmcnt(0)
    s_cmp_lt_u32 s62, 512
    s_cbranch_scc1 L_loop
    s_mov_b64 exec, 1
    ds_add_rtn_u32 v236, v233, v234 offset:4
    ds_add_rtn_u32 v241, v233, v234 offset:32
    s_mov_b64 exec, -1
    ds_read_b32 v108, v233 offset:12
    ds_read_b64 v[112:113], v240
    ds_read_b128 v[40:43], v7 offset:0
    ds_read_b128 v[44:47], v7 offset:1024
    ds_read_b128 v[48:51], v7 offset:2048
    ds_read_b128 v[52:55], v7 offset:3072
    s_waitcnt lgkmcnt(0)
    v_readfirstlane_b32 s63, v236
    s_cmp_lg_u32 s63, 3
    s_cbranch_scc1 L_stail
    s_mov_b32 s19, 1
    s_atomic_add s19, s[14:15], 0 glc
    s_branch L_stail
L_mix:
    s_waitcnt vmcnt(12)
    s_add_u32 s62, s62, 64
    s_cmp_ge_u32 s62, 528
    s_cselect_b32 s11, 1, 0
    s_cbranch_scc1 L_static
    s_mov_b32 s62, 1
    s_atomic_add s62, s[48:49], 0 glc
L_static:
    s_waitcnt vmcnt(8)
    ds_read_b128 v[40:43], v8 offset:0
    ds_read_b128 v[44:47], v9 offset:0
    ds_read_b128 v[48:51], v10 offset:0
    ds_read_b128 v[52:55], v11 offset:0
    ds_read_b128 v[56:59], v8 offset:4096
    ds_read_b128 v[60:63], v9 offset:4096
    ds_read_b128 v[64:67], v10 offset:4096
    ds_read_b128 v[68:71], v11 offset:4096
    ds_read_b32 v236, v233
    s_waitcnt lgkmcnt(8)
    v_mfma_f32_16x16x32_bf16 v[104:107], v[40:43], v[24:27], 0
    s_waitcnt lgkmcnt(7)
    v_mfma_f32_16x16x32_bf16 v[104:107], v[44:47], v[28:31], v[104:107]
    s_waitcnt lgkmcnt(6)
    v_mfma_f32_16x16x32_bf16 v[104:107], v[48:51], v[32:35], v[104:107]
    s_waitcnt lgkmcnt(5)
    v_mfma_f32_16x16x32_bf16 v[104:107], v[52:55], v[36:39], v[104:107]
    s_waitcnt lgkmcnt(4)
    v_mfma_f32_16x16x32_bf16 v[108:111], v[56:59], v[24:27], 0
    s_waitcnt lgkmcnt(3)
    v_mfma_f32_16x16x32_bf16 v[108:111], v[60:63], v[28:31], v[108:111]
    s_waitcnt lgkmcnt(2)
    v_mfma_f32_16x16x32_bf16 v[108:111], v[64:67], v[32:35], v[108:111]
    s_waitcnt lgkmcnt(1)
    v_mfma_f32_16x16x32_bf16 v[108:111], v[68:71], v[36:39], v[108:111]
    s_waitcnt vmcnt(4)
    s_mov_b64 exec, 1
    ds_add_u32 v233, v234
    s_mov_b64 exec, -1
    v_xor_b32 v8, 0x4000, v8
    v_xor_b32 v9, 0x4000, v9
    v_xor_b32 v10, 0x4000, v10
    v_xor_b32 v11, 0x4000, v11
    v_cvt_pk_bf16_f32 v120, v104, v105
    v_cvt_pk_bf16_f32 v121, v106, v107
    v_cvt_pk_bf16_f32 v122, v108, v109
    v_cvt_pk_bf16_f32 v123, v110, v111
    v_lshlrev_b32 v112, 16, v120
    v_and_b32 v113, 0xffff0000, v120
    v_lshlrev_b32 v114, 16, v121
    v_and_b32 v115, 0xffff0000, v121
    v_lshlrev_b32 v116, 16, v122
    v_and_b32 v117, 0xffff0000, v122
    v_lshlrev_b32 v118, 16, v123
    v_and_b32 v119, 0xffff0000, v123
    v_mul_f32 v112, s60, v112
    v_mul_f32 v113, s60, v113
    v_mul_f32 v114, s60, v114
    v_mul_f32 v115, s60, v115
    v_mul_f32 v116, s60, v116
    v_mul_f32 v117, s60, v117
    v_mul_f32 v118, s60, v118
    v_mul_f32 v119, s60, v119
    v_cvt_pk_bf16_f32 v120, v112, v113
    v_cvt_pk_bf16_f32 v121, v114, v115
    v_cvt_pk_bf16_f32 v122, v116, v117
    v_cvt_pk_bf16_f32 v123, v118, v119
    v_lshlrev_b32 v112, 16, v120
    v_and_b32 v113, 0xffff0000, v120
    v_lshlrev_b32 v114, 16, v121
    v_and_b32 v115, 0xffff0000, v121
    v_lshlrev_b32 v116, 16, v122
    v_and_b32 v117, 0xffff0000, v122
    v_lshlrev_b32 v118, 16, v123
    v_and_b32 v119, 0xffff0000, v123
    v_max3_f32 v22, v112, v113, v114
    v_max3_f32 v23, v115, v116, v117
    v_max3_f32 v22, v22, v118, v119
    v_max_f32 v22, v22, v23
    v_mov_b32 v23, v22
    s_nop 1
    v_permlane32_swap_b32 v23, v22
    v_max_f32 v22, v22, v23
    v_mov_b32 v23, v22
    s_nop 1
    v_permlane16_swap_b32 v23, v22
    v_max_f32 v22, v22, v23
    v_max_f32 v23, v22, v20
    v_sub_f32 v22, v20, v23
    v_mul_f32 v22, s61, v22
    v_exp_f32 v22, v22
    v_mov_b32 v20, v23
    v_sub_f32 v112, v112, v23
    v_sub_f32 v113, v113, v23
    v_sub_f32 v114, v114, v23
    v_sub_f32 v115, v115, v23
    v_sub_f32 v116, v116, v23
PL3:
    s_cbranch_execz L_ret2
    v_sub_f32 v117, v117, v23
    v_sub_f32 v118, v118, v23
    v_sub_f32 v119, v119, v23
    v_mul_f32 v112, s61, v112
    v_mul_f32 v113, s61, v113
    v_mul_f32 v114, s61, v114
    v_mul_f32 v115, s61, v115
    v_mul_f32 v116, s61, v116
    v_mul_f32 v117, s61, v117
    v_mul_f32 v118, s61, v118
    v_mul_f32 v119, s61, v119
    v_exp_f32 v112, v112
    v_exp_f32 v113, v113
    v_exp_f32 v114, v114
    v_exp_f32 v115, v115
    v_exp_f32 v116, v116
    v_exp_f32 v117, v117
    v_exp_f32 v118, v118
    v_exp_f32 v119, v119
    v_cvt_pk_bf16_f32 v120, v112, v113
    v_cvt_pk_bf16_f32 v121, v114, v115
    v_cvt_pk_bf16_f32 v122, v116, v117
    v_cvt_pk_bf16_f32 v123, v118, v119
    v_add_f32 v112, v112, v113
    v_add_f32 v114, v114, v115
    v_add_f32 v116, v116, v117
    v_add_f32 v118, v118, v119
    v_add_f32 v112, v112, v114
    v_add_f32 v116, v116, v118
    v_add_f32 v112, v112, v116
    v_fma_f32 v21, v21, v22, v112
    s_cmp_eq_u32 s11, 0
    s_cbranch_scc1 L_pv
    s_mov_b64 exec, 1
    ds_add_rtn_u32 v236, v233, v234 offset:4
    s_mov_b64 exec, -1
    ds_read_b32 v108, v233 offset:12
    ds_read_b64 v[112:113], v240
    ds_read_b128 v[40:43], v7 offset:0
    ds_read_b128 v[44:47], v7 offset:1024
    ds_read_b128 v[48:51], v7 offset:2048
    ds_read_b128 v[52:55], v7 offset:3072
L_pv:
    s_waitcnt vmcnt(0)
    ds_read_b64_tr_b16 v[72:73], v12 offset:8192
    ds_read_b64_tr_b16 v[74:75], v12 offset:12288
    ds_read_b64_tr_b16 v[76:77], v13 offset:8192
    ds_read_b64_tr_b16 v[78:79], v13 offset:12288
    ds_read_b64_tr_b16 v[80:81], v14 offset:8192
    ds_read_b64_tr_b16 v[82:83], v14 offset:12288
    ds_read_b64_tr_b16 v[84:85], v15 offset:8192
    ds_read_b64_tr_b16 v[86:87], v15 offset:12288
    ds_read_b64_tr_b16 v[88:89], v16 offset:8192
    ds_read_b64_tr_b16 v[90:91], v16 offset:12288
    ds_read_b64_tr_b16 v[92:93], v17 offset:8192
    ds_read_b64_tr_b16 v[94:95], v17 offset:12288
    ds_read_b64_tr_b16 v[96:97], v18 offset:8192
    ds_read_b64_tr_b16 v[98:99], v18 offset:12288
    ds_read_b64_tr_b16 v[100:101], v19 offset:8192
    ds_read_b64_tr_b16 v[102:103], v19 offset:12288
    ds_read_b32 v109, v233
    v_pk_mul_f32 v[124:125], v[124:125], v[22:23] op_sel_hi:[1,0]
    v_pk_mul_f32 v[126:127], v[126:127], v[22:23] op_sel_hi:[1,0]
    v_pk_mul_f32 v[128:129], v[128:129], v[22:23] op_sel_hi:[1,0]
    v_pk_mul_f32 v[130:131], v[130:131], v[22:23] op_sel_hi:[1,0]
    v_pk_mul_f32 v[132:133], v[132:133], v[22:23] op_sel_hi:[1,0]
    v_pk_mul_f32 v[134:135], v[134:135], v[22:23] op_sel_hi:[1,0]
    v_pk_mul_f32 v[136:137], v[136:137], v[22:23] op_sel_hi:[1,0]
    v_pk_mul_f32 v[138:139], v[138:139], v[22:23] op_sel_hi:[1,0]
    v_pk_mul_f32 v[140:141], v[140:141], v[22:23] op_sel_hi:[1,0]
    v_pk_mul_f32 v[142:143], v[142:143], v[22:23] op_sel_hi:[1,0]
    v_pk_mul_f32 v[144:145], v[144:145], v[22:23] op_sel_hi:[1,0]
    v_pk_mul_f32 v[146:147], v[146:147], v[22:23] op_sel_hi:[1,0]
    v_pk_mul_f32 v[148:149], v[148:149], v[22:23] op_sel_hi:[1,0]
    v_pk_mul_f32 v[150:151], v[150:151], v[22:23] op_sel_hi:[1,0]
    v_pk_mul_f32 v[152:153], v[152:153], v[22:23] op_sel_hi:[1,0]
    v_pk_mul_f32 v[154:155], v[154:155], v[22:23] op_sel_hi:[1,0]
    s_waitcnt lgkmcnt(14)
    v_mfma_f32_16x16x32_bf16 v[124:127], v[72:75], v[120:123], v[124:127]
    v_xor_b32 v12, 0x4000, v12
    s_cmp_eq_u32 s11, 0
    s_cbranch_scc1 L_noat
    v_readfirstlane_b32 s63, v236
    s_cmp_lg_u32 s63, 3
    s_cbranch_scc1 L_noat
    s_mov_b32 s19, 1
    s_atomic_add s19, s[14:15], 0 glc
L_noat:
    s_waitcnt lgkmcnt(13)
    v_mfma_f32_16x16x32_bf16 v[128:131], v[76:79], v[120:123], v[128:131]
    v_xor_b32 v13, 0x4000, v13
    s_waitcnt lgkmcnt(11)
    v_mfma_f32_16x16x32_bf16 v[132:135], v[80:83], v[120:123], v[132:135]
    v_xor_b32 v14, 0x4000, v14
    s_waitcnt lgkmcnt(9)
    v_mfma_f32_16x16x32_bf16 v[136:139], v[84:87], v[120:123], v[136:139]
    v_xor_b32 v15, 0x4000, v15
    s_waitcnt lgkmcnt(7)
    v_mfma_f32_16x16x32_bf16 v[140:143], v[88:91], v[120:123], v[140:143]
    v_xor_b32 v16, 0x4000, v16
    s_waitcnt lgkmcnt(5)
    v_mfma_f32_16x16x32_bf16 v[144:147], v[92:95], v[120:123], v[144:147]
    v_xor_b32 v17, 0x4000, v17
    s_waitcnt lgkmcnt(3)
    v_mfma_f32_16x16x32_bf16 v[148:151], v[96:99], v[120:123], v[148:151]
    v_xor_b32 v18, 0x4000, v18
    s_waitcnt lgkmcnt(1)
    v_mfma_f32_16x16x32_bf16 v[152:155], v[100:103], v[120:123], v[152:155]
    v_xor_b32 v19, 0x4000, v19
    s_add_u32 s33, s33, 1
    s_cmp_eq_u32 s11, 0
    s_cbranch_scc1 L_vend
    s_branch L_stail
L_e1:
.p2align 12
L_aux:
PA0:
    s_cbranch_execz L_ret1
    s_mov_b32 s37, 0xffffff00
    s_movk_i32 s38, 0xff
    v_and_b32 v4, 1, v0
    v_cmp_eq_u32 vcc, 1, v4
    v_mov_b32 v5, 0x0c0c0100
    v_mov_b32 v6, 0x01000c0c
    v_cndmask_b32 v5, v5, v6, vcc
    v_mov_b32 v6, 0x0c0c0302
    v_mov_b32 v7, 0x03020c0c
    v_cndmask_b32 v6, v6, v7, vcc
    v_bfe_u32 v4, v0, 1, 2
    v_mov_b32 v7, 0x0c0c0c0c
    v_cmp_eq_u32 vcc, 0, v4
    s_nop 1
    v_cndmask_b32 v148, v7, v5, vcc
    v_cndmask_b32 v149, v7, v6, vcc
    v_cmp_eq_u32 vcc, 1, v4
    s_nop 1
    v_cndmask_b32 v150, v7, v5, vcc
    v_cndmask_b32 v151, v7, v6, vcc
    v_cmp_eq_u32 vcc, 2, v4
    s_nop 1
    v_cndmask_b32 v152, v7, v5, vcc
    v_cndmask_b32 v153, v7, v6, vcc
    v_cmp_eq_u32 vcc, 3, v4
    s_nop 1
    v_cndmask_b32 v154, v7, v5, vcc
    v_cndmask_b32 v155, v7, v6, vcc
    s_and_b32 s59, s2, 7
    s_lshl3_add_u32 s31, s28, s59
    s_sub_u32 s59, s59, s28
    s_sub_u32 s59, s59, s28
    s_sub_u32 s59, s59, 2
    s_and_b32 s59, s59, 7
    s_mul_i32 s58, s28, 6
    s_add_u32 s58, s58, s59
    s_add_u32 s58, s58, 32
    s_cmp_lt_u32 s59, 6
    s_cselect_b32 s58, s58, 63
    s_bitcmp1_b32 s2, 5
    s_cselect_b32 s31, s58, s31
    s_lshl_b32 s58, s3, 10
    s_add_u32 s58, s58, 137728
    v_lshl_add_u32 v2, v0, 4, s58
    v_bfe_u32 v3, v0, 1, 3
    v_and_b32 v1, 1, v0
    v_lshl_add_u32 v3, v1, 4, v3
    v_lshlrev_b32 v3, 4, v3
    v_add_u32 v3, 137728, v3
    s_lshl2_add_u32 s58, s29, s3
    s_mul_i32 s59, s58, 458752
    s_lshl_b32 s58, s31, 7
    s_add_u32 s59, s59, s58
    s_add_u32 s40, s16, s59
    s_addc_u32 s41, s17, 0
    s_add_u32 s44, s18, s59
    s_addc_u32 s45, s19, 0
    s_cmp_lt_u32 s31, 56
    s_cselect_b32 s42, 458752, 0
    s_mov_b32 s46, s42
    s_mov_b32 s43, 0x20000
    s_mov_b32 s47, 0x20000
    v_lshrrev_b32 v1, 3, v0
    v_and_b32 v4, 7, v0
    v_lshlrev_b32 v5, 4, v4
    v_mul_u32_u24 v200, 57344, v1
    v_add_u32 v200, v200, v5
    s_waitcnt vmcnt(9)
    v_lshlrev_b32 v160, 16, v8
    v_and_b32 v161, 0xffff0000, v8
    v_lshlrev_b32 v162, 16, v9
    v_and_b32 v163, 0xffff0000, v9
    v_lshlrev_b32 v164, 16, v10
    v_and_b32 v165, 0xffff0000, v10
    v_lshlrev_b32 v166, 16, v11
    v_and_b32 v167, 0xffff0000, v11
    v_lshlrev_b32 v168, 16, v12
    v_and_b32 v169, 0xffff0000, v12
    v_lshlrev_b32 v170, 16, v13
    v_and_b32 v171, 0xffff0000, v13
    v_lshlrev_b32 v172, 16, v14
    v_and_b32 v173, 0xffff0000, v14
    v_lshlrev_b32 v174, 16, v15
    v_and_b32 v175, 0xffff0000, v15
    v_add_f32 v1, v160, v161
    v_add_f32 v5, v162, v163
    v_add_f32 v1, v1, v164
    v_add_f32 v5, v5, v165
    v_add_f32 v1, v1, v166
    v_add_f32 v5, v5, v167
    v_add_f32 v1, v1, v168
    v_add_f32 v5, v5, v169
    v_add_f32 v1, v1, v170
    v_add_f32 v5, v5, v171
    v_add_f32 v1, v1, v172
    v_add_f32 v5, v5, v173
    v_add_f32 v1, v1, v174
    v_add_f32 v5, v5, v175
    v_add_f32 v1, v1, v5
    s_nop 1
    v_add_f32_dpp v1, v1, v1 row_ror:8 row_mask:0xf bank_mask:0xf
    s_nop 1
    v_add_f32_dpp v1, v1, v1 row_ror:4 row_mask:0xf bank_mask:0xf
    s_nop 1
    v_add_f32_dpp v1, v1, v1 row_ror:2 row_mask:0xf bank_mask:0xf
    s_nop 1
    v_add_f32_dpp v1, v1, v1 row_ror:1 row_mask:0xf bank_mask:0xf
    v_mov_b32 v5, v1
    s_nop 1
    v_permlane32_swap_b32 v5, v1
    v_add_f32 v1, v1, v5
    v_mov_b32 v5, v1
    s_nop 1
    v_permlane16_swap_b32 v5, v1
    v_add_f32 v1, v1, v5
    v_mul_f32 v1, 0x3a800000, v1
    v_sub_f32 v160, v160, v1
    v_sub_f32 v161, v161, v1
    v_sub_f32 v162, v162, v1
    v_sub_f32 v163, v163, v1
    v_sub_f32 v164, v164, v1
    v_sub_f32 v165, v165, v1
    v_sub_f32 v166, v166, v1
    v_sub_f32 v167, v167, v1
    v_sub_f32 v168, v168, v1
    v_sub_f32 v169, v169, v1
    v_sub_f32 v170, v170, v1
    v_sub_f32 v171, v171, v1
    v_sub_f32 v172, v172, v1
    v_sub_f32 v173, v173, v1
    v_sub_f32 v174, v174, v1
    v_sub_f32 v175, v175, v1
    v_mul_f32 v6, v160, v160
    v_mul_f32 v5, v161, v161
    v_fmac_f32 v6, v162, v162
    v_fmac_f32 v5, v163, v163
    v_fmac_f32 v6, v164, v164
    v_fmac_f32 v5, v165, v165
    v_fmac_f32 v6, v166, v166
    v_fmac_f32 v5, v167, v167
    v_fmac_f32 v6, v168, v168
    v_fmac_f32 v5, v169, v169
    v_fmac_f32 v6, v170, v170
    v_fmac_f32 v5, v171, v171
    v_fmac_f32 v6, v172, v172
    v_fmac_f32 v5, v173, v173
    v_fmac_f32 v6, v174, v174
    v_fmac_f32 v5, v175, v175
    v_add_f32 v6, v6, v5
    s_nop 1
    v_add_f32_dpp v6, v6, v6 row_ror:8 row_mask:0xf bank_mask:0xf
    s_nop 1
    v_add_f32_dpp v6, v6, v6 row_ror:4 row_mask:0xf bank_mask:0xf
    s_nop 1
    v_add_f32_dpp v6, v6, v6 row_ror:2 row_mask:0xf bank_mask:0xf
    s_nop 1
    v_add_f32_dpp v6, v6, v6 row_ror:1 row_mask:0xf bank_mask:0xf
    v_mov_b32 v5, v6
    s_nop 1
    v_permlane32_swap_b32 v5, v6
    v_add_f32 v6, v6, v5
    v_mov_b32 v5, v6
    s_nop 1
    v_permlane16_swap_b32 v5, v6
    v_add_f32 v6, v6, v5
    v_mul_f32 v6, 0x3a800000, v6
    v_cvt_pk_bf16_f32 v1, v1, v1
    v_and_b32 v1, 0xffff0000, v1
    v_cvt_pk_bf16_f32 v6, v6, v6
    v_and_b32 v6, 0xffff0000, v6
    v_add_f32 v6, 0x3727c5ac, v6
    v_cvt_pk_bf16_f32 v6, v6, v6
    v_and_b32 v6, 0xffff0000, v6
    v_sqrt_f32 v6, v6
    s_nop 0
    v_cvt_pk_bf16_f32 v6, v6, v6
    v_and_b32 v6, 0xffff0000, v6
    v_rcp_f32 v6, v6
    s_waitcnt vmcnt(8)
    v_lshlrev_b32 v160, 16, v16
    v_and_b32 v161, 0xffff0000, v16
    v_lshlrev_b32 v162, 16, v17
    v_and_b32 v163, 0xffff0000, v17
    v_lshlrev_b32 v164, 16, v18
    v_and_b32 v165, 0xffff0000, v18
    v_lshlrev_b32 v166, 16, v19
    v_and_b32 v167, 0xffff0000, v19
    v_sub_f32 v160, v160, v1
    v_sub_f32 v161, v161, v1
    v_sub_f32 v162, v162, v1
    v_sub_f32 v163, v163, v1
    v_sub_f32 v164, v164, v1
    v_sub_f32 v165, v165, v1
    v_sub_f32 v166, v166, v1
    v_sub_f32 v167, v167, v1
    v_cvt_pk_bf16_f32 v16, v160, v161
    v_cvt_pk_bf16_f32 v17, v162, v163
    v_cvt_pk_bf16_f32 v18, v164, v165
    v_cvt_pk_bf16_f32 v19, v166, v167
    v_lshlrev_b32 v160, 16, v16
    v_and_b32 v161, 0xffff0000, v16
    v_lshlrev_b32 v162, 16, v17
    v_and_b32 v163, 0xffff0000, v17
    v_lshlrev_b32 v164, 16, v18
    v_and_b32 v165, 0xffff0000, v18
    v_lshlrev_b32 v166, 16, v19
    v_and_b32 v167, 0xffff0000, v19
    v_mul_f32 v160, v160, v6
    v_mul_f32 v161, v161, v6
    v_mul_f32 v162, v162, v6
    v_mul_f32 v163, v163, v6
    v_mul_f32 v164, v164, v6
    v_mul_f32 v165, v165, v6
    v_mul_f32 v166, v166, v6
    v_mul_f32 v167, v167, v6
PA1:
    s_cbranch_execz L_ret1
    v_cvt_pk_bf16_f32 v16, v160, v161
    v_cvt_pk_bf16_f32 v17, v162, v163
    v_cvt_pk_bf16_f32 v18, v164, v165
    v_cvt_pk_bf16_f32 v19, v166, v167
    v_perm_b32 v52, v16, v16, v148
    v_perm_b32 v53, v16, v16, v150
    v_perm_b32 v54, v16, v16, v152
    v_perm_b32 v55, v16, v16, v154
    v_perm_b32 v56, v16, v16, v149
    v_perm_b32 v57, v16, v16, v151
    v_perm_b32 v58, v16, v16, v153
    v_perm_b32 v59, v16, v16, v155
    v_perm_b32 v60, v17, v17, v148
    v_perm_b32 v61, v17, v17, v150
    v_perm_b32 v62, v17, v17, v152
    v_perm_b32 v63, v17, v17, v154
    v_perm_b32 v64, v17, v17, v149
    v_perm_b32 v65, v17, v17, v151
    v_perm_b32 v66, v17, v17, v153
    v_perm_b32 v67, v17, v17, v155
    v_perm_b32 v68, v18, v18, v148
    v_perm_b32 v69, v18, v18, v150
    v_perm_b32 v70, v18, v18, v152
    v_perm_b32 v71, v18, v18, v154
    v_perm_b32 v72, v18, v18, v149
    v_perm_b32 v73, v18, v18, v151
    v_perm_b32 v74, v18, v18, v153
    v_perm_b32 v75, v18, v18, v155
    v_perm_b32 v76, v19, v19, v148
    v_perm_b32 v77, v19, v19, v150
    v_perm_b32 v78, v19, v19, v152
    v_perm_b32 v79, v19, v19, v154
    v_perm_b32 v80, v19, v19, v149
    v_perm_b32 v81, v19, v19, v151
    v_perm_b32 v82, v19, v19, v153
    v_perm_b32 v83, v19, v19, v155
    s_cmp_lt_u32 s31, 56
    s_cbranch_scc1 L_gd1
    s_waitcnt vmcnt(0)
L_gd1:
    s_waitcnt vmcnt(7)
    v_mfma_f32_16x16x32_bf16 v[160:163], v[52:55], v[20:23], 0
    s_waitcnt vmcnt(6)
    s_mov_b32 s48, 0
    buffer_load_dwordx4 v[84:87], v200, s[40:43], s48 offen nt
    s_add_u32 s48, s48, 7168
    v_mfma_f32_16x16x32_bf16 v[160:163], v[56:59], v[24:27], v[160:163]
    s_waitcnt vmcnt(6)
    buffer_load_dwordx4 v[88:91], v200, s[40:43], s48 offen nt
    s_add_u32 s48, s48, 7168
    v_mfma_f32_16x16x32_bf16 v[160:163], v[60:63], v[28:31], v[160:163]
    s_waitcnt vmcnt(6)
    buffer_load_dwordx4 v[92:95], v200, s[40:43], s48 offen nt
    s_add_u32 s48, s48, 7168
    v_mfma_f32_16x16x32_bf16 v[160:163], v[64:67], v[32:35], v[160:163]
    s_waitcnt vmcnt(6)
    buffer_load_dwordx4 v[96:99], v200, s[40:43], s48 offen nt
    s_add_u32 s48, s48, 7168
    v_mfma_f32_16x16x32_bf16 v[160:163], v[68:71], v[36:39], v[160:163]
    s_waitcnt vmcnt(6)
    buffer_load_dwordx4 v[100:103], v200, s[40:43], s48 offen nt
    s_add_u32 s48, s48, 7168
    v_mfma_f32_16x16x32_bf16 v[160:163], v[72:75], v[40:43], v[160:163]
    s_waitcnt vmcnt(6)
    buffer_load_dwordx4 v[104:107], v200, s[40:43], s48 offen nt
    s_add_u32 s48, s48, 7168
    v_mfma_f32_16x16x32_bf16 v[160:163], v[76:79], v[44:47], v[160:163]
    s_waitcnt vmcnt(6)
    buffer_load_dwordx4 v[108:111], v200, s[40:43], s48 offen nt
    s_add_u32 s48, s48, 7168
    v_mfma_f32_16x16x32_bf16 v[160:163], v[80:83], v[48:51], v[160:163]
    s_waitcnt lgkmcnt(0)
    s_add_u32 s36, s36, 0x01010101
    v_mov_b32 v156, s36
    s_lshr_b32 s58, s36, 8
    v_mov_b32 v157, s58
    s_lshr_b32 s58, s36, 16
    v_mov_b32 v158, s58
    s_lshr_b32 s58, s36, 24
    v_mov_b32 v159, s58
    v_mov_b32 v5, 147104
    v_mov_b32 v6, 1
    ds_write_b128 v2, v[160:163]
    s_mov_b64 exec, 1
    ds_add_u32 v5, v6 offset:20
    s_mov_b64 exec, -1
    s_cmp_lg_u32 s3, 0
    s_cbranch_scc1 L_qpub
L_xw:
    ds_read_b32 v6, v5 offset:20
    s_waitcnt lgkmcnt(0)
    v_cmp_ne_u32 vcc, 5, v6
    s_cbranch_vccnz L_xw
    ds_read_b128 v[160:163], v3 offset:0
    ds_read_b128 v[164:167], v3 offset:640
    ds_read_b128 v[168:171], v3 offset:1024
    ds_read_b128 v[172:175], v3 offset:1664
    ds_read_b128 v[176:179], v3 offset:2048
    ds_read_b128 v[180:183], v3 offset:2688
    ds_read_b128 v[184:187], v3 offset:3072
    ds_read_b128 v[188:191], v3 offset:3712
    s_lshl4_add_u32 s58, s28, s30
    s_lshl2_add_u32 s58, s58, s29
    s_lshl_b32 s58, s58, 8
    s_add_u32 s58, s58, 65536
    v_lshl_add_u32 v1, v0, 4, s58
    s_waitcnt lgkmcnt(0)
    v_add_f32 v160, v160, v176
    v_add_f32 v161, v161, v177
    v_add_f32 v162, v162, v178
    v_add_f32 v163, v163, v179
    v_add_f32 v164, v164, v180
    v_add_f32 v165, v165, v181
    v_add_f32 v166, v166, v182
    v_add_f32 v167, v167, v183
    v_add_f32 v168, v168, v184
    v_add_f32 v169, v169, v185
    v_add_f32 v170, v170, v186
    v_add_f32 v171, v171, v187
    v_add_f32 v172, v172, v188
    v_add_f32 v173, v173, v189
    v_add_f32 v174, v174, v190
    v_add_f32 v175, v175, v191
    v_add_f32 v160, v160, v168
    v_add_f32 v161, v161, v169
    v_add_f32 v162, v162, v170
    v_add_f32 v163, v163, v171
    v_add_f32 v164, v164, v172
    v_add_f32 v165, v165, v173
    v_add_f32 v166, v166, v174
    v_add_f32 v167, v167, v175
    v_add_f32 v160, v160, v164
    v_add_f32 v161, v161, v165
    v_add_f32 v162, v162, v166
    v_add_f32 v163, v163, v167
    v_bfi_b32 v160, s37, v160, v156
    v_bfi_b32 v161, s37, v161, v157
    v_bfi_b32 v162, s37, v162, v158
    v_bfi_b32 v163, s37, v163, v159
    s_mov_b64 exec, 0xffff
    global_store_dwordx4 v1, v[160:163], s[26:27] sc1
    s_mov_b64 exec, -1
L_qpub:
    s_lshl2_add_u32 s58, s28, s3
    s_lshl_b32 s58, s58, 12
    s_add_u32 s58, s58, 65536
    v_lshrrev_b32 v1, 4, v0
    v_and_b32 v4, 15, v0
    v_lshl_add_u32 v4, v4, 4, s58
    v_lshl_add_u32 v4, v1, 10, v4
    v_mov_b32 v19, 147104
    v_mov_b32 v20, 1
    s_waitcnt vmcnt(6)
    buffer_load_dwordx4 v[112:115], v200, s[40:43], s48 offen nt
    s_waitcnt vmcnt(6)
    s_mov_b32 s48, 0
    buffer_load_dwordx4 v[116:119], v200, s[44:47], s48 offen nt
    s_add_u32 s48, s48, 7168
    s_waitcnt vmcnt(6)
    buffer_load_dwordx4 v[120:123], v200, s[44:47], s48 offen nt
    s_add_u32 s48, s48, 7168
    s_waitcnt vmcnt(6)
    buffer_load_dwordx4 v[124:127], v200, s[44:47], s48 offen nt
    s_add_u32 s48, s48, 7168
    s_waitcnt vmcnt(6)
    buffer_load_dwordx4 v[128:131], v200, s[44:47], s48 offen nt
    s_add_u32 s48, s48, 7168
    s_waitcnt vmcnt(6)
    buffer_load_dwordx4 v[132:135], v200, s[44:47], s48 offen nt
    s_add_u32 s48, s48, 7168
    s_waitcnt vmcnt(6)
    buffer_load_dwordx4 v[136:139], v200, s[44:47], s48 offen nt
    s_add_u32 s48, s48, 7168
    s_waitcnt vmcnt(6)
    buffer_load_dwordx4 v[140:143], v200, s[44:47], s48 offen nt
    s_add_u32 s48, s48, 7168
PA2:
    s_cbranch_execz PL2
    s_waitcnt vmcnt(6)
    buffer_load_dwordx4 v[144:147], v200, s[44:47], s48 offen nt
    s_waitcnt vmcnt(4)
    s_mov_b64 exec, 1
    ds_add_u32 v19, v20
    s_mov_b64 exec, -1
    s_waitcnt vmcnt(0)
    s_cmp_lt_u32 s31, 56
    s_cbranch_scc1 L_qgo
L_lw:
    s_sleep 4
    ds_read_b32 v6, v19
    s_waitcnt lgkmcnt(0)
    v_cmp_gt_u32 vcc, 9, v6
    s_cbranch_vccnz L_lw
L_qgo:
    s_mov_b32 s62, 0
    global_load_dwordx4 v[160:163], v4, s[26:27] offset:0 sc1
    global_load_dwordx4 v[164:167], v4, s[26:27] offset:256 sc1
    global_load_dwordx4 v[168:171], v4, s[26:27] offset:512 sc1
    global_load_dwordx4 v[172:175], v4, s[26:27] offset:768 sc1
    s_branch L_chk0
L_poll0:
    s_mov_b64 exec, s[40:41]
    s_cbranch_execz L_pl0_0
    global_load_dwordx4 v[160:163], v4, s[26:27] offset:0 sc1
L_pl0_0:
    s_mov_b64 exec, s[42:43]
    s_cbranch_execz L_pl0_1
    global_load_dwordx4 v[164:167], v4, s[26:27] offset:256 sc1
L_pl0_1:
    s_mov_b64 exec, s[44:45]
    s_cbranch_execz L_pl0_2
    global_load_dwordx4 v[168:171], v4, s[26:27] offset:512 sc1
L_pl0_2:
    s_mov_b64 exec, s[46:47]
    s_cbranch_execz L_pl0_3
    global_load_dwordx4 v[172:175], v4, s[26:27] offset:768 sc1
L_pl0_3:
    s_mov_b64 exec, -1
L_chk0:
    s_waitcnt vmcnt(0)
    v_xor_b32 v6, v160, v156
    v_bitop3_b32 v6, v161, v157, v6 bitop3:0xbe
    v_bitop3_b32 v6, v162, v158, v6 bitop3:0xbe
    v_bitop3_b32 v6, v163, v159, v6 bitop3:0xbe
    v_and_b32 v6, s38, v6
    v_cmp_ne_u32 s[40:41], 0, v6
    v_xor_b32 v6, v164, v156
    v_bitop3_b32 v6, v165, v157, v6 bitop3:0xbe
    v_bitop3_b32 v6, v166, v158, v6 bitop3:0xbe
    v_bitop3_b32 v6, v167, v159, v6 bitop3:0xbe
    v_and_b32 v6, s38, v6
    v_cmp_ne_u32 s[42:43], 0, v6
    v_xor_b32 v6, v168, v156
    v_bitop3_b32 v6, v169, v157, v6 bitop3:0xbe
    v_bitop3_b32 v6, v170, v158, v6 bitop3:0xbe
    v_bitop3_b32 v6, v171, v159, v6 bitop3:0xbe
    v_and_b32 v6, s38, v6
    v_cmp_ne_u32 s[44:45], 0, v6
    v_xor_b32 v6, v172, v156
    v_bitop3_b32 v6, v173, v157, v6 bitop3:0xbe
    v_bitop3_b32 v6, v174, v158, v6 bitop3:0xbe
    v_bitop3_b32 v6, v175, v159, v6 bitop3:0xbe
    v_and_b32 v6, s38, v6
    v_cmp_ne_u32 s[46:47], 0, v6
    s_or_b64 vcc, s[40:41], s[42:43]
    s_or_b64 vcc, vcc, s[44:45]
    s_or_b64 vcc, vcc, s[46:47]
    s_cbranch_scc0 L_pok0
    s_add_u32 s62, s62, 1
    s_cmp_ge_u32 s62, 0x200000
    s_sleep 4
    s_cbranch_scc0 L_poll0
L_pok0:
    v_and_b32 v160, s37, v160
    v_and_b32 v161, s37, v161
    v_and_b32 v162, s37, v162
    v_and_b32 v163, s37, v163
    v_and_b32 v164, s37, v164
    v_and_b32 v165, s37, v165
    v_and_b32 v166, s37, v166
    v_and_b32 v167, s37, v167
    v_and_b32 v168, s37, v168
    v_and_b32 v169, s37, v169
    v_and_b32 v170, s37, v170
    v_and_b32 v171, s37, v171
    v_and_b32 v172, s37, v172
    v_and_b32 v173, s37, v173
    v_and_b32 v174, s37, v174
    v_and_b32 v175, s37, v175
    v_add_f32 v160, v160, v168
    v_add_f32 v161, v161, v169
    v_add_f32 v162, v162, v170
    v_add_f32 v163, v163, v171
    v_add_f32 v164, v164, v172
    v_add_f32 v165, v165, v173
    v_add_f32 v166, v166, v174
    v_add_f32 v167, v167, v175
    v_add_f32 v160, v160, v164
    v_add_f32 v161, v161, v165
    v_add_f32 v162, v162, v166
    v_add_f32 v163, v163, v167
    v_cvt_pk_bf16_f32 v160, v160, v161
    v_cvt_pk_bf16_f32 v161, v162, v163
    s_lshl_b32 s58, s3, 9
    s_add_u32 s58, s58, 135680
    v_lshl_add_u32 v1, v0, 3, s58
    ds_write_b64 v1, v[160:161]
    v_mov_b32 v5, 147104
    v_mov_b32 v6, 1
    s_mov_b64 exec, 1
    ds_add_u32 v5, v6 offset:8
    s_mov_b64 exec, -1
    s_cmp_ge_u32 s31, 56
    s_cbranch_scc1 L_gpd
    v_and_b32 v4, 7, v0
    s_lshl2_add_u32 s58, s31, s29
    s_lshl_b32 s58, s58, 9
    s_add_u32 s58, s58, 2621440
    v_lshl_add_u32 v5, v4, 5, s58
    v_bfe_u32 v4, v0, 4, 1
    v_lshl_add_u32 v5, v4, 4, v5
    v_lshrrev_b32 v4, 5, v0
    v_lshl_add_u32 v5, v4, 8, v5
    s_waitcnt vmcnt(0)
    v_mfma_f32_16x16x32_bf16 v[160:163], v[52:55], v[84:87], 0
    v_mfma_f32_16x16x32_bf16 v[160:163], v[56:59], v[88:91], v[160:163]
    v_mfma_f32_16x16x32_bf16 v[160:163], v[60:63], v[92:95], v[160:163]
    v_mfma_f32_16x16x32_bf16 v[160:163], v[64:67], v[96:99], v[160:163]
    v_mfma_f32_16x16x32_bf16 v[160:163], v[68:71], v[100:103], v[160:163]
    v_mfma_f32_16x16x32_bf16 v[160:163], v[72:75], v[104:107], v[160:163]
    v_mfma_f32_16x16x32_bf16 v[160:163], v[76:79], v[108:111], v[160:163]
    v_mfma_f32_16x16x32_bf16 v[160:163], v[80:83], v[112:115], v[160:163]
    v_mfma_f32_16x16x32_bf16 v[164:167], v[52:55], v[116:119], 0
    v_mfma_f32_16x16x32_bf16 v[164:167], v[56:59], v[120:123], v[164:167]
    v_mfma_f32_16x16x32_bf16 v[164:167], v[60:63], v[124:127], v[164:167]
    v_mfma_f32_16x16x32_bf16 v[164:167], v[64:67], v[128:131], v[164:167]
    v_mfma_f32_16x16x32_bf16 v[164:167], v[68:71], v[132:135], v[164:167]
    v_mfma_f32_16x16x32_bf16 v[164:167], v[72:75], v[136:139], v[164:167]
    v_mfma_f32_16x16x32_bf16 v[164:167], v[76:79], v[140:143], v[164:167]
    v_mfma_f32_16x16x32_bf16 v[164:167], v[80:83], v[144:147], v[164:167]
    s_nop 7
    v_permlane32_swap_b32 v160, v164
    v_permlane32_swap_b32 v161, v165
    v_permlane32_swap_b32 v162, v166
    v_permlane32_swap_b32 v163, v167
    v_add_f32_dpp v160, v164, v160 row_ror:8 row_mask:0xf bank_mask:0xf
    v_add_f32_dpp v161, v165, v161 row_ror:8 row_mask:0xf bank_mask:0xf
    v_add_f32_dpp v162, v166, v162 row_ror:8 row_mask:0xf bank_mask:0xf
    v_add_f32_dpp v163, v167, v163 row_ror:8 row_mask:0xf bank_mask:0xf
    ds_write_b128 v2, v[160:163] offset:4096
    s_mov_b64 exec, 1
    ds_add_rtn_u32 v6, v19, v20 offset:16
    s_mov_b64 exec, -1
    v_lshlrev_b32 v7, 4, v0
    v_add_u32 v7, 141824, v7
    s_waitcnt lgkmcnt(0)
    v_readfirstlane_b32 s58, v6
    s_cmp_lg_u32 s58, 3
    s_cbranch_scc1 L_gpd
    ds_read_b128 v[160:163], v7 offset:0
    ds_read_b128 v[164:167], v7 offset:1024
    ds_read_b128 v[168:171], v7 offset:2048
    ds_read_b128 v[172:175], v7 offset:3072
    s_waitcnt lgkmcnt(0)
    v_add_f32 v160, v160, v168
    v_add_f32 v161, v161, v169
    v_add_f32 v162, v162, v170
    v_add_f32 v163, v163, v171
    v_add_f32 v164, v164, v172
    v_add_f32 v165, v165, v173
    v_add_f32 v166, v166, v174
    v_add_f32 v167, v167, v175
    v_add_f32 v160, v160, v164
    v_add_f32 v161, v161, v165
    v_add_f32 v162, v162, v166
    v_add_f32 v163, v163, v167
    v_bfi_b32 v160, s37, v160, v156
    v_bfi_b32 v161, s37, v161, v157
    v_bfi_b32 v162, s37, v162, v158
    v_bfi_b32 v163, s37, v163, v159
    s_mov_b32 exec_lo, 0x00ff00ff
    s_mov_b32 exec_hi, 0x00ff00ff
    global_store_dwordx4 v5, v[160:163], s[26:27] sc1
    s_mov_b64 exec, -1
L_gpd:
    s_cmp_lg_u32 s3, 0
    s_cbranch_scc1 L_noffn
    s_lshl4_add_u32 s58, s28, s30
    s_mul_i32 s58, s58, 14
    v_and_b32 v4, 15, v0
    v_min_u32 v5, 13, v4
    v_add_u32 v5, s58, v5
    v_lshrrev_b32 v6, 4, v5
    v_and_b32 v5, 15, v5
    v_lshlrev_b32 v5, 4, v5
    v_lshl_add_u32 v5, v6, 11, v5
    v_lshrrev_b32 v1, 4, v0
    v_lshl_add_u32 v5, v1, 9, v5
    v_add_u32 v5, 2621440, v5
L_gt:
    s_sleep 20
    ds_read_b64 v[22:23], v19
PA3:
    s_cbranch_execz PL3
    s_waitcnt lgkmcnt(0)
    v_cmp_gt_u32 vcc, 40, v22
    v_cmp_eq_u32 s[58:59], 0, v23
    s_and_b64 vcc, vcc, s[58:59]
    s_cbranch_scc1 L_gt
    s_mov_b32 s62, 0
    global_load_dwordx4 v[160:163], v5, s[26:27] offset:0 sc1
    global_load_dwordx4 v[164:167], v5, s[26:27] offset:256 sc1
    s_branch L_chk1
L_poll1:
    s_mov_b64 exec, s[40:41]
    s_cbranch_execz L_pl1_0
    global_load_dwordx4 v[160:163], v5, s[26:27] offset:0 sc1
L_pl1_0:
    s_mov_b64 exec, s[42:43]
    s_cbranch_execz L_pl1_1
    global_load_dwordx4 v[164:167], v5, s[26:27] offset:256 sc1
L_pl1_1:
    s_mov_b64 exec, -1
L_chk1:
    s_waitcnt vmcnt(0)
    v_xor_b32 v193, v160, v156
    v_bitop3_b32 v193, v161, v157, v193 bitop3:0xbe
    v_bitop3_b32 v193, v162, v158, v193 bitop3:0xbe
    v_bitop3_b32 v193, v163, v159, v193 bitop3:0xbe
    v_and_b32 v193, s38, v193
    v_cmp_ne_u32 s[40:41], 0, v193
    v_xor_b32 v193, v164, v156
    v_bitop3_b32 v193, v165, v157, v193 bitop3:0xbe
    v_bitop3_b32 v193, v166, v158, v193 bitop3:0xbe
    v_bitop3_b32 v193, v167, v159, v193 bitop3:0xbe
    v_and_b32 v193, s38, v193
    v_cmp_ne_u32 s[42:43], 0, v193
    s_or_b64 vcc, s[40:41], s[42:43]
    s_cbranch_scc0 L_pok1
    s_add_u32 s62, s62, 1
    s_cmp_ge_u32 s62, 0x200000
    s_sleep 10
    s_cbranch_scc0 L_poll1
L_pok1:
    v_and_b32 v160, s37, v160
    v_and_b32 v161, s37, v161
    v_and_b32 v162, s37, v162
    v_and_b32 v163, s37, v163
    v_and_b32 v164, s37, v164
    v_and_b32 v165, s37, v165
    v_and_b32 v166, s37, v166
    v_and_b32 v167, s37, v167
    v_permlane32_swap_b32 v160, v162
    v_permlane32_swap_b32 v161, v163
    v_permlane32_swap_b32 v164, v166
    v_permlane32_swap_b32 v165, v167
    v_add_f32 v160, v160, v162
    v_add_f32 v161, v161, v163
    v_add_f32 v164, v164, v166
    v_add_f32 v165, v165, v167
    v_permlane16_swap_b32 v160, v161
    s_nop 0
    v_permlane16_swap_b32 v164, v165
    v_add_f32 v160, v160, v161
    v_add_f32 v164, v164, v165
    v_cvt_pk_bf16_f32 v160, v160, v160
    v_and_b32 v160, 0xffff0000, v160
    v_cvt_pk_bf16_f32 v164, v164, v164
    v_and_b32 v164, 0xffff0000, v164
    v_mul_f32 v161, v160, v160
    v_mov_b32 v162, 0xc0135761
    v_mul_f32 v161, 0xbdd2d3e8, v161
    v_add_f32 v161, v161, v162
    v_mul_f32 v161, v161, v160
    v_exp_f32 v161, v161
    s_nop 0
    v_add_f32 v161, 1.0, v161
    v_rcp_f32 v161, v161
    s_nop 0
    v_mul_f32 v160, v160, v161
    v_cvt_pk_bf16_f32 v160, v160, v160
    v_and_b32 v160, 0xffff0000, v160
    v_mul_f32 v160, v160, v164
    v_cvt_pk_bf16_f32 v160, v160, v160
    v_lshl_add_u32 v4, v4, 2, v1
    v_lshlrev_b32 v4, 1, v4
    v_add_u32 v4, 146976, v4
    ds_write_b16 v4, v160
    v_mov_b32 v4, 147104
    v_mov_b32 v5, 1
    ds_write_b32 v4, v5 offset:24
    s_branch L_noffn
L_e2:
.p2align 12
L_noffn:
    s_mov_b64 exec, 0
    s_branch PT0
L_ret3:
    s_mov_b64 exec, -1
    s_lshl4_add_u32 s58, s28, s30
    s_lshl2_add_u32 s58, s58, s3
    s_mul_i32 s58, s58, 6144
    s_add_u32 s58, s58, 1051648
    v_lshrrev_b32 v1, 4, v0
    v_and_b32 v4, 15, v0
    v_mul_u32_u24 v5, 384, v1
    v_add_u32 v5, s58, v5
    v_lshl_add_u32 v8, v4, 4, v5
    v_and_b32 v6, 3, v0
    v_mul_u32_u24 v6, 1536, v6
    v_add_u32 v10, v5, v6
    s_lshl_b32 s58, s3, 3
    s_add_u32 s58, s58, 146944
    v_mov_b32 v9, s58
    v_lshl_add_u32 v5, v4, 2, v1
    s_lshl_b32 s58, s3, 8
    s_add_u32 s58, s58, 145920
    v_lshl_add_u32 v11, v5, 2, s58
    s_and_b32 s58, s2, 7
    s_lshl_b32 s58, s58, 5
    s_lshr_b32 s59, s2, 3
    s_add_u32 s63, s58, s59
    s_lshr_b32 s58, s63, 3
    s_lshl_b32 s58, s58, 14
    s_and_b32 s59, s63, 7
    s_lshl4_add_u32 s58, s59, s58
    s_add_u32 s58, s58, 524288
    v_lshl_add_u32 v12, v0, 7, s58
    s_add_u32 s58, s58, 8192
    v_lshl_add_u32 v13, v0, 7, s58
    s_lshl_b32 s63, s63, 3
    v_lshl_add_u32 v15, v1, 1, s63
    global_load_ushort v14, v15, s[4:5]
    s_lshl_b32 s58, s2, 7
    s_add_u32 s58, s58, 262144
    s_add_u32 s34, s26, s58
    s_addc_u32 s35, s27, 0
    s_mov_b32 s61, 0x3fb8aa3b
    s_mov_b32 s37, 0xfffffc00
    s_movk_i32 s38, 1023
    v_lshlrev_b32 v16, 2, v0
    v_add_u32 v16, 137728, v16
    v_mov_b32 v5, 147104
L_aw:
    s_sleep 30
    ds_read_b32 v6, v5 offset:4
    s_waitcnt lgkmcnt(0)
    v_cmp_eq_u32 vcc, 0, v6
    s_cbranch_vccnz L_aw
L_aw2:
    s_sleep 2
    ds_read_b32 v6, v5 offset:4
    s_waitcnt lgkmcnt(0)
    v_cmp_gt_u32 vcc, 5, v6
    s_cbranch_vccnz L_aw2
    s_mov_b32 s62, 0
L_hint:
    s_load_dword s58, s[34:35], 0 glc
    s_waitcnt lgkmcnt(0)
    s_cmp_eq_u32 s58, s36
    s_cbranch_scc1 L_hinted
    s_sleep 1
    s_add_u32 s62, s62, 1
    s_cmp_ge_u32 s62, 0x100
    s_cbranch_scc0 L_hint
L_hinted:
    s_mov_b32 s62, 0
    global_load_dwordx4 v[176:179], v10, s[26:27] offset:-2816 sc1
    global_load_dwordx4 v[160:163], v8, s[26:27] offset:-3072 sc1
    global_load_dwordx4 v[164:167], v8, s[26:27] offset:-1536 sc1
    global_load_dwordx4 v[168:171], v8, s[26:27] offset:0 sc1
    global_load_dwordx4 v[172:175], v8, s[26:27] offset:1536 sc1
    s_branch L_c1
L_rp:
    v_and_b32 v24, s38, v24
    v_cmp_ne_u32 s[40:41], 0, v24
    v_and_b32 v25, s38, v25
    v_cmp_ne_u32 s[42:43], 0, v25
    v_and_b32 v26, s38, v26
    v_cmp_ne_u32 s[44:45], 0, v26
    v_and_b32 v27, s38, v27
    v_cmp_ne_u32 s[46:47], 0, v27
    v_and_b32 v28, s38, v28
    v_cmp_ne_u32 s[48:49], 0, v28
    s_add_u32 s62, s62, 1
    s_cmp_ge_u32 s62, 0x200000
    s_cbranch_scc1 L_c2
    s_sleep 1
    s_mov_b64 exec, s[40:41]
    s_cbranch_execz L_rp0
    global_load_dwordx4 v[176:179], v10, s[26:27] offset:-2816 sc1
L_rp0:
    s_mov_b64 exec, s[42:43]
    s_cbranch_execz L_rp1
    global_load_dwordx4 v[160:163], v8, s[26:27] offset:-3072 sc1
L_rp1:
    s_mov_b64 exec, s[44:45]
    s_cbranch_execz L_rp2
    global_load_dwordx4 v[164:167], v8, s[26:27] offset:-1536 sc1
L_rp2:
    s_mov_b64 exec, s[46:47]
    s_cbranch_execz L_rp3
    global_load_dwordx4 v[168:171], v8, s[26:27] offset:0 sc1
L_rp3:
    s_mov_b64 exec, s[48:49]
    s_cbranch_execz L_rp4
    global_load_dwordx4 v[172:175], v8, s[26:27] offset:1536 sc1
L_rp4:
    s_mov_b64 exec, -1
    s_waitcnt vmcnt(0)
L_c1:
    s_waitcnt vmcnt(4)
    v_and_b32 v22, s37, v176
    v_xor_b32 v24, v176, v156
    v_bitop3_b32 v24, v177, v157, v24 bitop3:0xbe
    v_max_f32_dpp v6, v22, v22 quad_perm:[1,0,3,2] row_mask:0xf bank_mask:0xf
    v_bitop3_b32 v24, v178, v158, v24 bitop3:0xbe
    v_bitop3_b32 v24, v179, v159, v24 bitop3:0xbe
    s_waitcnt vmcnt(3)
    v_max_f32_dpp v6, v6, v6 quad_perm:[2,3,0,1] row_mask:0xf bank_mask:0xf
    v_mov_b32 v7, v6
    v_xor_b32 v25, v160, v156
    v_bitop3_b32 v25, v161, v157, v25 bitop3:0xbe
    v_permlane32_swap_b32 v7, v6
    v_max_f32 v6, v6, v7
    v_mov_b32 v7, v6
    v_bitop3_b32 v25, v162, v158, v25 bitop3:0xbe
    v_bitop3_b32 v25, v163, v159, v25 bitop3:0xbe
    s_waitcnt vmcnt(2)
    v_permlane16_swap_b32 v7, v6
    v_max_f32 v6, v6, v7
    v_sub_f32 v5, v22, v6
    v_mul_f32 v5, s61, v5
    v_exp_f32 v5, v5
    v_and_b32 v23, s37, v177
    v_and_b32 v32, s37, v160
    v_and_b32 v33, s37, v161
    v_and_b32 v34, s37, v162
    v_and_b32 v35, s37, v163
    v_xor_b32 v26, v164, v156
    v_bitop3_b32 v26, v165, v157, v26 bitop3:0xbe
    v_bitop3_b32 v26, v166, v158, v26 bitop3:0xbe
    v_bitop3_b32 v26, v167, v159, v26 bitop3:0xbe
    v_mul_f32 v7, v5, v23
    v_mul_f32_dpp v180, v5, v32 quad_perm:[0,0,0,0] row_mask:0xf bank_mask:0xf
    v_mul_f32_dpp v181, v5, v33 quad_perm:[0,0,0,0] row_mask:0xf bank_mask:0xf
    v_mul_f32_dpp v182, v5, v34 quad_perm:[0,0,0,0] row_mask:0xf bank_mask:0xf
    v_mul_f32_dpp v183, v5, v35 quad_perm:[0,0,0,0] row_mask:0xf bank_mask:0xf
    v_and_b32 v36, s37, v164
    v_and_b32 v37, s37, v165
    v_and_b32 v38, s37, v166
    v_and_b32 v39, s37, v167
    v_add_f32_dpp v7, v7, v7 quad_perm:[1,0,3,2] row_mask:0xf bank_mask:0xf
    s_waitcnt vmcnt(1)
    v_xor_b32 v27, v168, v156
    v_bitop3_b32 v27, v169, v157, v27 bitop3:0xbe
    v_bitop3_b32 v27, v170, v158, v27 bitop3:0xbe
    v_bitop3_b32 v27, v171, v159, v27 bitop3:0xbe
    v_and_b32 v40, s37, v168
    v_and_b32 v41, s37, v169
    v_and_b32 v42, s37, v170
    v_and_b32 v43, s37, v171
    v_add_f32_dpp v7, v7, v7 quad_perm:[2,3,0,1] row_mask:0xf bank_mask:0xf
    s_waitcnt vmcnt(0)
    v_xor_b32 v28, v172, v156
    v_bitop3_b32 v28, v173, v157, v28 bitop3:0xbe
    v_bitop3_b32 v28, v174, v158, v28 bitop3:0xbe
    v_bitop3_b32 v28, v175, v159, v28 bitop3:0xbe
    v_mov_b32 v21, v7
    v_or3_b32 v29, v24, v25, v26
    v_or3_b32 v29, v29, v27, v28
    v_and_b32 v29, s38, v29
    v_cmp_ne_u32 vcc, 0, v29
    s_cbranch_vccnz L_rp
L_c2:
    v_permlane32_swap_b32 v21, v7
    v_and_b32 v44, s37, v172
    v_and_b32 v45, s37, v173
    v_and_b32 v46, s37, v174
    v_and_b32 v47, s37, v175
    v_fmac_f32_dpp v180, v5, v36 quad_perm:[1,1,1,1] row_mask:0xf bank_mask:0xf
    v_fmac_f32_dpp v181, v5, v37 quad_perm:[1,1,1,1] row_mask:0xf bank_mask:0xf
    v_fmac_f32_dpp v182, v5, v38 quad_perm:[1,1,1,1] row_mask:0xf bank_mask:0xf
    v_fmac_f32_dpp v183, v5, v39 quad_perm:[1,1,1,1] row_mask:0xf bank_mask:0xf
    v_add_f32 v7, v7, v21
    v_mov_b32 v21, v7
    v_fmac_f32_dpp v180, v5, v40 quad_perm:[2,2,2,2] row_mask:0xf bank_mask:0xf
    v_fmac_f32_dpp v181, v5, v41 quad_perm:[2,2,2,2] row_mask:0xf bank_mask:0xf
    v_fmac_f32_dpp v182, v5, v42 quad_perm:[2,2,2,2] row_mask:0xf bank_mask:0xf
    v_fmac_f32_dpp v183, v5, v43 quad_perm:[2,2,2,2] row_mask:0xf bank_mask:0xf
    v_permlane16_swap_b32 v21, v7
    v_fmac_f32_dpp v180, v5, v44 quad_perm:[3,3,3,3] row_mask:0xf bank_mask:0xf
    v_fmac_f32_dpp v181, v5, v45 quad_perm:[3,3,3,3] row_mask:0xf bank_mask:0xf
    v_fmac_f32_dpp v182, v5, v46 quad_perm:[3,3,3,3] row_mask:0xf bank_mask:0xf
    v_fmac_f32_dpp v183, v5, v47 quad_perm:[3,3,3,3] row_mask:0xf bank_mask:0xf
    v_add_f32 v7, v7, v21
    ds_write_b64 v9, v[6:7]
    v_permlane32_swap_b32 v180, v182
    v_permlane32_swap_b32 v181, v183
    v_add_f32 v180, v180, v182
    v_add_f32 v181, v181, v183
    s_nop 1
PT0:
    s_cbranch_execz PT1
    v_permlane16_swap_b32 v180, v181
    v_add_f32 v180, v180, v181
    ds_write_b32 v11, v180
    s_waitcnt lgkmcnt(0)
    s_barrier
    s_cmp_eq_u32 s3, 0
    s_cbranch_scc1 L_sred
    s_cmp_lg_u32 s3, 1
    s_cbranch_scc1 L_end
    s_mov_b32 s62, 0
L_poll2:
    global_load_dwordx4 v[164:167], v13, s[26:27] sc1
    s_waitcnt vmcnt(0)
    v_xor_b32 v6, v164, v156
    v_bitop3_b32 v6, v165, v157, v6 bitop3:0xbe
    v_bitop3_b32 v6, v166, v158, v6 bitop3:0xbe
    v_bitop3_b32 v6, v167, v159, v6 bitop3:0xbe
    v_and_b32 v6, s38, v6
    v_cmp_ne_u32 vcc, 0, v6
    s_cbranch_vccz L_pok2
    s_mov_b64 exec, vcc
    s_add_u32 s62, s62, 1
    s_cmp_ge_u32 s62, 0x200000
    s_sleep 1
    s_cbranch_scc0 L_poll2
L_pok2:
    s_mov_b64 exec, -1
    v_and_b32 v164, s37, v164
    v_and_b32 v165, s37, v165
    v_and_b32 v166, s37, v166
    v_and_b32 v167, s37, v167
    s_nop 0
    v_permlane32_swap_b32 v164, v166
    v_permlane32_swap_b32 v165, v167
    v_add_f32 v164, v164, v166
    v_add_f32 v165, v165, v167
    s_nop 1
    v_permlane16_swap_b32 v164, v165
    v_add_f32 v164, v164, v165
    s_nop 1
    v_add_f32_dpp v164, v164, v164 row_ror:8 row_mask:0xf bank_mask:0xf
    s_nop 1
    v_add_f32_dpp v164, v164, v164 row_ror:4 row_mask:0xf bank_mask:0xf
    s_nop 1
    v_add_f32_dpp v164, v164, v164 row_ror:2 row_mask:0xf bank_mask:0xf
    s_nop 1
    v_add_f32_dpp v164, v164, v164 row_ror:1 row_mask:0xf bank_mask:0xf
    v_cvt_pk_bf16_f32 v164, v164, v164
    v_and_b32 v164, 0xffff0000, v164
    v_mul_f32 v21, 0xbfb8aa3b, v164
    v_exp_f32 v21, v21
    s_nop 0
    v_add_f32 v21, 1.0, v21
    v_rcp_f32 v21, v21
    s_nop 0
    v_mul_f32 v21, v21, v164
    v_cvt_pk_bf16_f32 v21, v21, v21
    v_and_b32 v21, 0xffff0000, v21
    ds_write_b32 v16, v21
    s_waitcnt lgkmcnt(0)
    s_barrier
    s_endpgm
L_sred:
    v_lshlrev_b32 v14, 16, v14
    s_mov_b32 s62, 0
L_poll3:
    global_load_dwordx4 v[160:163], v12, s[26:27] sc1
    s_waitcnt vmcnt(0)
    v_xor_b32 v6, v160, v156
    v_bitop3_b32 v6, v161, v157, v6 bitop3:0xbe
    v_bitop3_b32 v6, v162, v158, v6 bitop3:0xbe
    v_bitop3_b32 v6, v163, v159, v6 bitop3:0xbe
    v_and_b32 v6, s38, v6
    v_cmp_ne_u32 vcc, 0, v6
    s_cbranch_vccz L_pok3
    s_mov_b64 exec, vcc
    s_add_u32 s62, s62, 1
    s_cmp_ge_u32 s62, 0x200000
    s_sleep 1
    s_cbranch_scc0 L_poll3
L_pok3:
    s_mov_b64 exec, -1
    s_barrier
    ds_read_b32 v21, v16
    v_and_b32 v160, s37, v160
    v_and_b32 v161, s37, v161
    v_and_b32 v162, s37, v162
    v_and_b32 v163, s37, v163
    s_nop 0
    v_permlane32_swap_b32 v160, v162
    v_permlane32_swap_b32 v161, v163
    v_add_f32 v160, v160, v162
    v_add_f32 v161, v161, v163
    s_nop 1
    v_permlane16_swap_b32 v160, v161
    v_add_f32 v160, v160, v161
    s_nop 1
    v_add_f32_dpp v160, v160, v160 row_ror:8 row_mask:0xf bank_mask:0xf
    s_nop 1
    v_add_f32_dpp v160, v160, v160 row_ror:4 row_mask:0xf bank_mask:0xf
    s_nop 1
    v_add_f32_dpp v160, v160, v160 row_ror:2 row_mask:0xf bank_mask:0xf
    s_nop 1
    v_add_f32_dpp v160, v160, v160 row_ror:1 row_mask:0xf bank_mask:0xf
    v_cvt_pk_bf16_f32 v160, v160, v160
    v_and_b32 v160, 0xffff0000, v160
    s_waitcnt lgkmcnt(0)
    v_mul_f32 v5, v21, v160
    v_cvt_pk_bf16_f32 v5, v5, v5
    v_and_b32 v5, 0xffff0000, v5
    v_add_f32 v5, v5, v14
    v_cvt_pk_bf16_f32 v5, v5, v5
    s_mov_b32 exec_lo, 0x00010001
    s_mov_b32 exec_hi, 0x00010001
    global_store_short v15, v5, s[22:23]
    s_cmp_lg_u32 s2, 0
    s_cbranch_scc1 L_fin
    s_mov_b64 exec, 1
    v_mov_b32 v5, 0
    v_mov_b32 v6, s36
    global_store_dword v5, v6, s[26:27] sc1
L_fin:
L_end:
    s_endpgm
L_stail:
    v_readfirstlane_b32 s33, v236
    v_mov_b32 v23, v21
    s_nop 1
    v_permlane32_swap_b32 v23, v21
    v_add_f32 v21, v21, v23
    v_mov_b32 v23, v21
    s_nop 1
    v_permlane16_swap_b32 v23, v21
    v_add_f32 v21, v21, v23
    s_cmp_eq_u32 s33, 0
    s_cbranch_scc1 L_first
    v_cmp_ne_u32 vcc, s33, v108
    s_cbranch_vccz L_pw2
L_pw:
    ds_read_b32 v108, v233 offset:12
    ds_read_b64 v[112:113], v240
    ds_read_b128 v[40:43], v7 offset:0
    ds_read_b128 v[44:47], v7 offset:1024
    ds_read_b128 v[48:51], v7 offset:2048
    ds_read_b128 v[52:55], v7 offset:3072
    ds_read_b32 v109, v233
    s_waitcnt lgkmcnt(1)
    v_cmp_ne_u32 vcc, s33, v108
    s_cbranch_vccnz L_pw
L_pw2:
    v_max_f32 v104, v112, v20
    v_sub_f32 v20, v20, v104
    v_sub_f32 v112, v112, v104
    v_mul_f32 v20, s61, v20
    v_mul_f32 v112, s61, v112
    v_exp_f32 v20, v20
    v_exp_f32 v112, v112
    v_cndmask_b32 v124, v124, v128, s[20:21]
    v_cndmask_b32 v125, v125, v129, s[20:21]
    v_cndmask_b32 v126, v126, v130, s[20:21]
    v_cndmask_b32 v127, v127, v131, s[20:21]
    v_cndmask_b32 v132, v132, v136, s[20:21]
    v_cndmask_b32 v133, v133, v137, s[20:21]
    v_cndmask_b32 v134, v134, v138, s[20:21]
    v_cndmask_b32 v135, v135, v139, s[20:21]
    v_cndmask_b32 v140, v140, v144, s[20:21]
    v_cndmask_b32 v141, v141, v145, s[20:21]
    v_cndmask_b32 v142, v142, v146, s[20:21]
    v_cndmask_b32 v143, v143, v147, s[20:21]
    v_cndmask_b32 v148, v148, v152, s[20:21]
    v_cndmask_b32 v149, v149, v153, s[20:21]
    v_cndmask_b32 v150, v150, v154, s[20:21]
    v_cndmask_b32 v151, v151, v155, s[20:21]
    v_mul_f32 v105, v20, v21
    v_fmac_f32 v105, v112, v113
    v_pk_mul_f32 v[40:41], v[40:41], v[112:113] op_sel_hi:[1,0]
    v_pk_mul_f32 v[42:43], v[42:43], v[112:113] op_sel_hi:[1,0]
    v_pk_mul_f32 v[44:45], v[44:45], v[112:113] op_sel_hi:[1,0]
    v_pk_mul_f32 v[46:47], v[46:47], v[112:113] op_sel_hi:[1,0]
    v_pk_mul_f32 v[48:49], v[48:49], v[112:113] op_sel_hi:[1,0]
    v_pk_mul_f32 v[50:51], v[50:51], v[112:113] op_sel_hi:[1,0]
    v_pk_mul_f32 v[52:53], v[52:53], v[112:113] op_sel_hi:[1,0]
    v_pk_mul_f32 v[54:55], v[54:55], v[112:113] op_sel_hi:[1,0]
    s_cmp_eq_u32 s33, 3
    s_cbranch_scc1 L_last
    v_pk_fma_f32 v[124:125], v[124:125], v[20:21], v[40:41] op_sel_hi:[1,0,1]
    v_pk_fma_f32 v[126:127], v[126:127], v[20:21], v[42:43] op_sel_hi:[1,0,1]
    v_pk_fma_f32 v[132:133], v[132:133], v[20:21], v[44:45] op_sel_hi:[1,0,1]
    v_pk_fma_f32 v[134:135], v[134:135], v[20:21], v[46:47] op_sel_hi:[1,0,1]
    v_pk_fma_f32 v[140:141], v[140:141], v[20:21], v[48:49] op_sel_hi:[1,0,1]
    v_pk_fma_f32 v[142:143], v[142:143], v[20:21], v[50:51] op_sel_hi:[1,0,1]
    v_pk_fma_f32 v[148:149], v[148:149], v[20:21], v[52:53] op_sel_hi:[1,0,1]
    v_pk_fma_f32 v[150:151], v[150:151], v[20:21], v[54:55] op_sel_hi:[1,0,1]
    s_branch L_wr
L_first:
    v_cndmask_b32 v124, v124, v128, s[20:21]
    v_cndmask_b32 v125, v125, v129, s[20:21]
    v_cndmask_b32 v126, v126, v130, s[20:21]
    v_cndmask_b32 v127, v127, v131, s[20:21]
    v_cndmask_b32 v132, v132, v136, s[20:21]
    v_cndmask_b32 v133, v133, v137, s[20:21]
    v_cndmask_b32 v134, v134, v138, s[20:21]
PT1:
    s_cbranch_execz PT2
    v_cndmask_b32 v135, v135, v139, s[20:21]
    v_cndmask_b32 v140, v140, v144, s[20:21]
    v_cndmask_b32 v141, v141, v145, s[20:21]
    v_cndmask_b32 v142, v142, v146, s[20:21]
    v_cndmask_b32 v143, v143, v147, s[20:21]
    v_cndmask_b32 v148, v148, v152, s[20:21]
    v_cndmask_b32 v149, v149, v153, s[20:21]
    v_cndmask_b32 v150, v150, v154, s[20:21]
    v_cndmask_b32 v151, v151, v155, s[20:21]
    v_mov_b32 v104, v20
    v_mov_b32 v105, v21
L_wr:
    ds_write_b128 v7, v[124:127] offset:0
    ds_write_b128 v7, v[132:135] offset:1024
    ds_write_b128 v7, v[140:143] offset:2048
    ds_write_b128 v7, v[148:151] offset:3072
    ds_write_b64 v240, v[104:105]
    s_mov_b64 exec, 1
    ds_add_u32 v233, v234 offset:12
    s_mov_b64 exec, -1
    s_branch L_nt
L_last:
    v_pk_fma_f32 v[124:125], v[124:125], v[20:21], v[40:41] op_sel_hi:[1,0,1]
    v_pk_fma_f32 v[126:127], v[126:127], v[20:21], v[42:43] op_sel_hi:[1,0,1]
    v_bfi_b32 v124, v235, v124, s36
    v_bfi_b32 v125, v235, v125, s16
    v_bfi_b32 v126, v235, v126, s17
    v_bfi_b32 v127, v235, v127, s18
    global_store_dwordx4 v231, v[124:127], s[26:27] offset:0 sc1
    v_pk_fma_f32 v[132:133], v[132:133], v[20:21], v[44:45] op_sel_hi:[1,0,1]
    v_pk_fma_f32 v[134:135], v[134:135], v[20:21], v[46:47] op_sel_hi:[1,0,1]
    v_bfi_b32 v132, v235, v132, s36
    v_bfi_b32 v133, v235, v133, s16
    v_bfi_b32 v134, v235, v134, s17
    v_bfi_b32 v135, v235, v135, s18
    global_store_dwordx4 v231, v[132:135], s[26:27] offset:128 sc1
    v_pk_fma_f32 v[140:141], v[140:141], v[20:21], v[48:49] op_sel_hi:[1,0,1]
    v_pk_fma_f32 v[142:143], v[142:143], v[20:21], v[50:51] op_sel_hi:[1,0,1]
    v_bfi_b32 v140, v235, v140, s36
    v_bfi_b32 v141, v235, v141, s16
    v_bfi_b32 v142, v235, v142, s17
    v_bfi_b32 v143, v235, v143, s18
    global_store_dwordx4 v238, v[140:143], s[26:27] offset:0 sc1
    v_pk_fma_f32 v[148:149], v[148:149], v[20:21], v[52:53] op_sel_hi:[1,0,1]
    v_pk_fma_f32 v[150:151], v[150:151], v[20:21], v[54:55] op_sel_hi:[1,0,1]
    v_bfi_b32 v148, v235, v148, s36
    v_bfi_b32 v149, v235, v149, s16
    v_bfi_b32 v150, v235, v150, s17
    v_bfi_b32 v151, v235, v151, s18
    global_store_dwordx4 v238, v[148:151], s[26:27] offset:128 sc1
    v_bfi_b32 v104, v235, v104, s36
    v_bfi_b32 v105, v235, v105, s16
    v_mov_b32 v106, s17
    v_mov_b32 v107, s18
    s_mov_b64 exec, 0xffff
    global_store_dwordx4 v232, v[104:107], s[26:27] offset:256 sc1
    s_mov_b64 exec, 1
    ds_add_u32 v233, v234 offset:4
    s_mov_b64 exec, -1
L_nt:
    s_waitcnt lgkmcnt(0)
    s_cmp_lg_u32 s19, 55
    s_cbranch_scc1 L_wj
    v_mov_b32 v22, s36
    global_store_dword v239, v22, s[26:27] sc1
L_wj:
    s_cmp_lt_i32 s19, 32
    s_cbranch_scc1 L_nr
    v_mov_b32 v22, 8
    s_mov_b64 exec, 1
    ds_add_u32 v233, v22
    s_mov_b64 exec, -1
L_nr:
    s_mov_b64 exec, 1
    ds_add_rtn_u32 v108, v233, v242 offset:28
    s_mov_b64 exec, -1
    s_waitcnt lgkmcnt(0)
    v_readfirstlane_b32 s39, v108
    s_add_u32 s39, s39, 10
    s_branch L_wa_c
L_wa:
    s_sleep 1
L_wa_c:
    ds_read_b32 v108, v233
    s_waitcnt lgkmcnt(0)
    v_cmp_gt_i32 vcc, s39, v108
    s_cbranch_vccnz L_wa
    buffer_load_dwordx4 v[156:159], v6, s[40:43], 0 offen offset:0 nt
    buffer_load_dwordx4 v[160:163], v6, s[40:43], 0 offen offset:2048 nt
    buffer_load_dwordx4 v[164:167], v6, s[40:43], s51 offen offset:0 nt
    buffer_load_dwordx4 v[168:171], v6, s[40:43], s51 offen offset:2048 nt
    buffer_load_dwordx4 v[172:175], v6, s[40:43], s52 offen offset:0 nt
    buffer_load_dwordx4 v[176:179], v6, s[40:43], s52 offen offset:2048 nt
    buffer_load_dwordx4 v[180:183], v6, s[40:43], s53 offen offset:0 nt
    buffer_load_dwordx4 v[184:187], v6, s[40:43], s53 offen offset:2048 nt
    s_add_u32 s39, s39, 1
    s_branch L_wb_c
L_wb:
    s_sleep 1
L_wb_c:
    ds_read_b32 v108, v233
    s_waitcnt lgkmcnt(0)
    v_cmp_gt_i32 vcc, s39, v108
    s_cbranch_vccnz L_wb
    buffer_load_dwordx4 v[188:191], v6, s[44:47], 0 offen offset:0 nt
    buffer_load_dwordx4 v[192:195], v6, s[44:47], 0 offen offset:2048 nt
    buffer_load_dwordx4 v[196:199], v6, s[44:47], s51 offen offset:0 nt
    buffer_load_dwordx4 v[200:203], v6, s[44:47], s51 offen offset:2048 nt
    buffer_load_dwordx4 v[204:207], v6, s[44:47], s52 offen offset:0 nt
    buffer_load_dwordx4 v[208:211], v6, s[44:47], s52 offen offset:2048 nt
    buffer_load_dwordx4 v[212:215], v6, s[44:47], s53 offen offset:0 nt
    buffer_load_dwordx4 v[216:219], v6, s[44:47], s53 offen offset:2048 nt
    s_waitcnt vmcnt(12)
    s_mov_b64 exec, 1
    ds_add_u32 v233, v234
    s_mov_b64 exec, -1
L_hw:
    ds_read_b32 v23, v233 offset:24
    ds_read_b128 v[120:123], v237
    s_waitcnt lgkmcnt(0)
    v_cmp_eq_u32 vcc, 0, v23
    s_cbranch_vccnz L_hw
    v_perm_b32 v40, v120, v120, v220
    v_perm_b32 v41, v120, v120, v222
    v_perm_b32 v42, v120, v120, v224
    v_perm_b32 v43, v120, v120, v226
    v_perm_b32 v44, v120, v120, v221
    v_perm_b32 v45, v120, v120, v223
    v_perm_b32 v46, v120, v120, v225
    v_perm_b32 v47, v120, v120, v227
    v_perm_b32 v48, v121, v121, v220
    v_perm_b32 v49, v121, v121, v222
    v_perm_b32 v50, v121, v121, v224
    v_perm_b32 v51, v121, v121, v226
    v_perm_b32 v52, v121, v121, v221
    v_perm_b32 v53, v121, v121, v223
    v_perm_b32 v54, v121, v121, v225
    v_perm_b32 v55, v121, v121, v227
    v_perm_b32 v56, v122, v122, v220
    v_perm_b32 v57, v122, v122, v222
    v_perm_b32 v58, v122, v122, v224
    v_perm_b32 v59, v122, v122, v226
    v_perm_b32 v60, v122, v122, v221
    v_perm_b32 v61, v122, v122, v223
    v_perm_b32 v62, v122, v122, v225
    v_perm_b32 v63, v122, v122, v227
    v_perm_b32 v64, v123, v123, v220
    v_perm_b32 v65, v123, v123, v222
    v_perm_b32 v66, v123, v123, v224
    v_perm_b32 v67, v123, v123, v226
    v_perm_b32 v68, v123, v123, v221
    v_perm_b32 v69, v123, v123, v223
    v_perm_b32 v70, v123, v123, v225
    v_perm_b32 v71, v123, v123, v227
    s_waitcnt vmcnt(8)
    v_mfma_f32_16x16x32_bf16 v[104:107], v[40:43], v[156:159], 0
    v_mfma_f32_16x16x32_bf16 v[104:107], v[44:47], v[160:163], v[104:107]
    v_mfma_f32_16x16x32_bf16 v[104:107], v[48:51], v[164:167], v[104:107]
    v_mfma_f32_16x16x32_bf16 v[104:107], v[52:55], v[168:171], v[104:107]
    v_mfma_f32_16x16x32_bf16 v[104:107], v[56:59], v[172:175], v[104:107]
    v_mfma_f32_16x16x32_bf16 v[104:107], v[60:63], v[176:179], v[104:107]
    v_mfma_f32_16x16x32_bf16 v[104:107], v[64:67], v[180:183], v[104:107]
    v_mfma_f32_16x16x32_bf16 v[104:107], v[68:71], v[184:187], v[104:107]
    s_waitcnt vmcnt(4)
    s_mov_b64 exec, 1
    ds_add_u32 v233, v234
    s_mov_b64 exec, -1
PT2:
    s_cbranch_execz PT3
    s_nop 3
    v_permlane32_swap_b32 v104, v106
    v_permlane32_swap_b32 v105, v107
    s_nop 0
    v_add_f32_dpp v104, v106, v104 row_ror:8 row_mask:0xf bank_mask:0xf
    v_add_f32_dpp v105, v107, v105 row_ror:8 row_mask:0xf bank_mask:0xf
    s_nop 0
    v_permlane32_swap_b32 v104, v106
    v_permlane32_swap_b32 v105, v107
    v_bfi_b32 v104, v235, v104, s36
    v_bfi_b32 v105, v235, v105, s16
    v_bfi_b32 v106, v235, v106, s17
    v_bfi_b32 v107, v235, v107, s18
    s_waitcnt vmcnt(0)
L_dst:
    s_mov_b64 exec, 0x00ff00ff
    global_store_dwordx4 v229, v[104:107], s[26:27] sc1
    s_mov_b64 exec, -1
    v_mov_b32 v7, 146944
    s_barrier
    ds_read_b128 v[112:115], v7
    ds_read_b128 v[116:119], v7 offset:16
    ds_read_b128 v[72:75], v230 offset:0
    ds_read_b128 v[76:79], v230 offset:16
    ds_read_b128 v[80:83], v230 offset:256
    ds_read_b128 v[84:87], v230 offset:272
    ds_read_b128 v[88:91], v230 offset:512
    ds_read_b128 v[92:95], v230 offset:528
    ds_read_b128 v[96:99], v230 offset:768
    ds_read_b128 v[100:103], v230 offset:784
    s_waitcnt lgkmcnt(8)
    v_max3_f32 v22, v112, v114, v116
    v_max_f32 v22, v22, v118
    v_sub_f32 v112, v112, v22
    v_sub_f32 v114, v114, v22
    v_sub_f32 v116, v116, v22
    v_sub_f32 v118, v118, v22
    v_mul_f32 v112, s61, v112
    v_mul_f32 v114, s61, v114
    v_mul_f32 v116, s61, v116
    v_mul_f32 v118, s61, v118
    v_exp_f32 v112, v112
    v_exp_f32 v114, v114
    v_exp_f32 v116, v116
    v_exp_f32 v118, v118
    v_mul_f32 v22, v112, v113
    v_fmac_f32 v22, v114, v115
    v_fmac_f32 v22, v116, v117
    v_fmac_f32 v22, v118, v119
    v_rcp_f32 v22, v22
    s_waitcnt lgkmcnt(0)
    v_pk_mul_f32 v[72:73], v[72:73], v[112:113] op_sel_hi:[1,0]
    v_pk_mul_f32 v[74:75], v[74:75], v[112:113] op_sel_hi:[1,0]
    v_pk_mul_f32 v[76:77], v[76:77], v[112:113] op_sel_hi:[1,0]
    v_pk_mul_f32 v[78:79], v[78:79], v[112:113] op_sel_hi:[1,0]
    v_pk_fma_f32 v[72:73], v[80:81], v[114:115], v[72:73] op_sel_hi:[1,0,1]
    v_pk_fma_f32 v[74:75], v[82:83], v[114:115], v[74:75] op_sel_hi:[1,0,1]
    v_pk_fma_f32 v[76:77], v[84:85], v[114:115], v[76:77] op_sel_hi:[1,0,1]
    v_pk_fma_f32 v[78:79], v[86:87], v[114:115], v[78:79] op_sel_hi:[1,0,1]
    v_pk_fma_f32 v[72:73], v[88:89], v[116:117], v[72:73] op_sel_hi:[1,0,1]
    v_pk_fma_f32 v[74:75], v[90:91], v[116:117], v[74:75] op_sel_hi:[1,0,1]
    v_pk_fma_f32 v[76:77], v[92:93], v[116:117], v[76:77] op_sel_hi:[1,0,1]
    v_pk_fma_f32 v[78:79], v[94:95], v[116:117], v[78:79] op_sel_hi:[1,0,1]
    v_pk_fma_f32 v[72:73], v[96:97], v[118:119], v[72:73] op_sel_hi:[1,0,1]
    v_pk_fma_f32 v[74:75], v[98:99], v[118:119], v[74:75] op_sel_hi:[1,0,1]
    v_pk_fma_f32 v[76:77], v[100:101], v[118:119], v[76:77] op_sel_hi:[1,0,1]
    v_pk_fma_f32 v[78:79], v[102:103], v[118:119], v[78:79] op_sel_hi:[1,0,1]
    v_pk_mul_f32 v[72:73], v[72:73], v[22:23] op_sel_hi:[1,0]
    v_pk_mul_f32 v[74:75], v[74:75], v[22:23] op_sel_hi:[1,0]
    v_pk_mul_f32 v[76:77], v[76:77], v[22:23] op_sel_hi:[1,0]
    v_pk_mul_f32 v[78:79], v[78:79], v[22:23] op_sel_hi:[1,0]
    v_cvt_pk_bf16_f32 v120, v72, v73
    v_cvt_pk_bf16_f32 v121, v74, v75
    v_cvt_pk_bf16_f32 v122, v76, v77
    v_cvt_pk_bf16_f32 v123, v78, v79
    v_perm_b32 v40, v120, v120, v220
    v_perm_b32 v41, v120, v120, v222
    v_perm_b32 v42, v120, v120, v224
    v_perm_b32 v43, v120, v120, v226
    v_perm_b32 v44, v120, v120, v221
    v_perm_b32 v45, v120, v120, v223
    v_perm_b32 v46, v120, v120, v225
    v_perm_b32 v47, v120, v120, v227
    v_mfma_f32_16x16x32_bf16 v[104:107], v[40:43], v[188:191], 0
    v_perm_b32 v48, v121, v121, v220
    v_perm_b32 v49, v121, v121, v222
    v_perm_b32 v50, v121, v121, v224
    v_perm_b32 v51, v121, v121, v226
    v_mfma_f32_16x16x32_bf16 v[104:107], v[44:47], v[192:195], v[104:107]
    v_perm_b32 v52, v121, v121, v221
    v_perm_b32 v53, v121, v121, v223
    v_perm_b32 v54, v121, v121, v225
    v_perm_b32 v55, v121, v121, v227
    v_mfma_f32_16x16x32_bf16 v[104:107], v[48:51], v[196:199], v[104:107]
    v_perm_b32 v56, v122, v122, v220
    v_perm_b32 v57, v122, v122, v222
    v_perm_b32 v58, v122, v122, v224
    v_perm_b32 v59, v122, v122, v226
    v_mfma_f32_16x16x32_bf16 v[104:107], v[52:55], v[200:203], v[104:107]
    v_perm_b32 v60, v122, v122, v221
    v_perm_b32 v61, v122, v122, v223
    v_perm_b32 v62, v122, v122, v225
    v_perm_b32 v63, v122, v122, v227
    v_mfma_f32_16x16x32_bf16 v[104:107], v[56:59], v[204:207], v[104:107]
    v_perm_b32 v64, v123, v123, v220
    v_perm_b32 v65, v123, v123, v222
    v_perm_b32 v66, v123, v123, v224
    v_perm_b32 v67, v123, v123, v226
    v_mfma_f32_16x16x32_bf16 v[104:107], v[60:63], v[208:211], v[104:107]
    v_perm_b32 v68, v123, v123, v221
    v_perm_b32 v69, v123, v123, v223
    v_perm_b32 v70, v123, v123, v225
    v_perm_b32 v71, v123, v123, v227
    v_mfma_f32_16x16x32_bf16 v[104:107], v[64:67], v[212:215], v[104:107]
    s_nop 0
    v_mfma_f32_16x16x32_bf16 v[104:107], v[68:71], v[216:219], v[104:107]
    s_nop 7
    v_permlane32_swap_b32 v104, v106
    v_permlane32_swap_b32 v105, v107
    s_nop 0
    v_add_f32_dpp v104, v106, v104 row_ror:8 row_mask:0xf bank_mask:0xf
    v_add_f32_dpp v105, v107, v105 row_ror:8 row_mask:0xf bank_mask:0xf
PT3:
    s_cbranch_execz L_ret3
    s_nop 0
    v_permlane32_swap_b32 v104, v106
    v_permlane32_swap_b32 v105, v107
    v_bfi_b32 v104, v235, v104, s36
    v_bfi_b32 v105, v235, v105, s16
    v_bfi_b32 v106, v235, v106, s17
    v_bfi_b32 v107, v235, v107, s18
    s_mov_b64 exec, 0x00ff00ff
    global_store_dwordx4 v228, v[104:107], s[26:27] sc1
    s_endpgm
.section .rodata,"a"
.p2align 6
.amdhsa_kernel recurrent_scan__gqa_block_cached__glu_gated_geglu__decode_kernel
.amdhsa_next_free_vgpr 248
.amdhsa_next_free_sgpr 102
.amdhsa_accum_offset 248
.amdhsa_group_segment_fixed_size 0
.amdhsa_kernarg_size 96
.amdhsa_user_sgpr_count 2
.amdhsa_user_sgpr_kernarg_segment_ptr 1
.amdhsa_system_sgpr_workgroup_id_x 1
.amdhsa_float_denorm_mode_32 3
.end_amdhsa_kernel
```
